```python
import torch

def _softmax(x, axis=-1):
    return torch.softmax(x, dim=axis)
def _gelu(x):
    return torch.nn.functional.gelu(x, approximate="tanh")
def _silu(x):
    return torch.nn.functional.silu(x)
def _sigmoid(x):
    return torch.sigmoid(x)
def _layernorm(x, axis=-1, eps=1e-5):
    m = x.mean(dim=axis, keepdim=True)
    v = x.var(dim=axis, keepdim=True, unbiased=False)
    return (x - m) / torch.sqrt(v + eps)
def _scatter_add(tgt, idx, src, axis=0):
    return tgt.clone().index_add_(axis, idx, src)
def _segment_sum(src, seg, n):
    out = torch.zeros((n,) + src.shape[1:], dtype=src.dtype)
    return out.index_add_(0, seg, src)
def _pad(x, pw):
    flat = tuple(v for pair in reversed(pw) for v in pair)
    return torch.nn.functional.pad(x, flat)

kernel_name = 'gated_mix__sliding_block__ssm_conv_h3__prompt'

def setup_inputs():

    _w = (lambda a: (lambda t: t.to(torch.bfloat16) if t.is_floating_point() else t)(torch.as_tensor(a)))
    def _A_setup():
        B, S, D = 1, 2048, 576
        return {
            "x": _w((lambda *s: torch.randn(*s, dtype=torch.bfloat16) * 0.05)(B, S, D)),
            "wqkv": _w((lambda *s: torch.randn(*s, dtype=torch.bfloat16) * 0.8)(D, 3 * D)),
            "wo": _w((lambda *s: torch.randn(*s, dtype=torch.bfloat16) * 0.05)(D, D)),
        }
    _A_in = _A_setup()

    def _B_setup():
        B, S, D = 1, 2048, 576
        ks = 4
        return {
            "q": _w((lambda *s: torch.randn(*s, dtype=torch.bfloat16) * 0.05)(B, S, D)),
            "k": _w((lambda *s: torch.randn(*s, dtype=torch.bfloat16) * 0.8)(B, S, D)),
            "v": _w((lambda *s: torch.randn(*s, dtype=torch.bfloat16) * 0.8)(B, S, D)),
            "shift_k": _w((lambda *s: torch.randn(*s, dtype=torch.bfloat16) * 0.8)(D, ks) * 0.5),
            "ssm_k": _w((lambda *s: torch.randn(*s, dtype=torch.bfloat16) * 1.6)(D, S) * (1.0 / S ** 0.5)),
            "ssm_D": _w((lambda *s: torch.randn(*s, dtype=torch.bfloat16) * 0.8)(D)),
        }
    _B_in = _B_setup()

    return {
        "A_x": _A_in["x"],
        "A_wqkv": _A_in["wqkv"],
        "A_wo": _A_in["wo"],
        "B_q": _B_in["q"],
        "B_k": _B_in["k"],
        "B_v": _B_in["v"],
        "B_shift_k": _B_in["shift_k"],
        "B_ssm_k": _B_in["ssm_k"],
        "B_ssm_D": _B_in["ssm_D"],
        "gate_w": _w((lambda *s: torch.randn(*s, dtype=torch.bfloat16) * 0.05)(576) * 16.0),
    }

def reference(A_x, A_wqkv, A_wo, B_q, B_k, B_v, B_shift_k, B_ssm_k, B_ssm_D, gate_w):
    def _A_ref(x, wqkv, wo):
        B, S, D = x.shape
        H = 32; Dh = D // H; W = 256
        qkv = (lambda x, *d: x.permute(*d))((x @ wqkv).reshape(B, S, 3, H, Dh), 2, 0, 3, 1, 4)
        q, k, v = qkv[0], qkv[1], qkv[2]
        scores = torch.einsum("bhqd,bhkd->bhqk", q, k) * (Dh ** -0.5)
        idx = torch.arange(S)
        mask = (idx[:, None] - idx[None, :] >= 0) & (idx[:, None] - idx[None, :] < W)
        scores = torch.where(mask[None, None], scores, -1e9)
        p = _softmax(scores, axis=-1)
        o = torch.einsum("bhqk,bhkd->bhqd", p, v)
        return (lambda x, *d: x.permute(*d))(o, 0, 2, 1, 3).reshape(B, S, D) @ wo

    def _B_ref(q, k, v, shift_k, ssm_k, ssm_D):
        B, S, D = q.shape
        ks = shift_k.shape[-1]
        k_pad = _pad(k, ((0, 0), (ks - 1, 0), (0, 0)))
        k_shift = torch.zeros_like(k)
        for t in range(ks):
            k_shift = k_shift + k_pad[:, t:t + S, :] * shift_k[:, ks - 1 - t][None, None, :]
        kv = k_shift * v
        L = 2 * S
        kv_pad = _pad(kv, ((0, 0), (0, S), (0, 0)))
        kf_pad = _pad(ssm_k, ((0, 0), (0, S)))
        kv_f = (lambda x, axes=(-2,-1): torch.fft.rfft2(x.float(), dim=axes))(kv_pad[:, None, :, :], axes=(1, 2))
        kf_f = (lambda x, axes=(-2,-1): torch.fft.rfft2(x.float(), dim=axes))(kf_pad[:, None, :], axes=(1, 2))
        kf_f = (lambda x, *d: x.permute(*d))(kf_f, 1, 2, 0)
        y_f = kv_f * kf_f[None, :, :, :]
        y = (lambda x, s, axes=(-2,-1): torch.fft.irfft2(x, s=s, dim=axes).to(torch.bfloat16))(y_f, (1, L), axes=(1, 2))[:, 0, :S, :]
        y = y + kv * ssm_D[None, None, :]
        return q * y

    x = A_x
    g = _sigmoid((x * gate_w).sum(-1, keepdims=True))
    a = _A_ref(x, A_wqkv, A_wo)
    b = _B_ref(x, B_k, B_v, B_shift_k, B_ssm_k, B_ssm_D)
    return g * a + (1 - g) * b
```

```asm
; @launch grid=(256,1,1) block=(512,1,1) lds=163840
.amdgcn_target "amdgcn-amd-amdhsa--gfx950"
.text
.globl gated_mix__sliding_block__ssm_conv_h3__prompt_kernel
.p2align 8
.type gated_mix__sliding_block__ssm_conv_h3__prompt_kernel,@function
gated_mix__sliding_block__ssm_conv_h3__prompt_kernel:
    s_cmp_ge_u32 s2, 256
    s_cbranch_scc1 L_end
    s_load_dwordx4 s[4:7], s[0:1], 0
    s_load_dwordx4 s[8:11], s[0:1], 32
    s_load_dwordx4 s[12:15], s[0:1], 48
    s_load_dwordx2 s[16:17], s[0:1], 96
    v_lshrrev_b32 v1, 6, v0
    v_and_b32 v0, 63, v0
    v_readfirstlane_b32 s18, v1
    v_lshlrev_b32 v12, 2, v0
    v_mov_b32 v13, 0
    ds_write_b32 v12, v13 offset:22016
    s_and_b32 s43, s2, 3
    s_lshl_b32 s43, s43, 2
    s_bfe_u32 s19, s2, 0x20003
    s_add_u32 s43, s43, s19
    s_bfe_u32 s44, s2, 0x10002
    s_mul_i32 s44, s44, 7
    s_lshr_b32 s45, s2, 5
    s_add_u32 s44, s44, s45
    s_and_b32 s95, s18, 3
    s_lshr_b32 s19, s18, 2
    s_lshl_b32 s91, s18, 13
    s_add_u32 s91, s91, 57344
    s_mul_i32 s92, s19, 4864
    s_lshl_b32 s93, s19, 2
    s_add_u32 s93, s93, 22016
    s_mov_b32 s96, 0
    s_mov_b32 s90, s19
    s_mov_b32 s94, 1
    s_lshl_b32 s3, s2, 1
    s_add_u32 s3, s3, s19
    s_add_u32 s3, s3, 128
    s_lshl_b32 s19, s18, 5
    s_and_b32 s20, s2, 31
    s_add_u32 s19, s19, s20
    s_lshl_b32 s20, s2, 2
    s_add_u32 s20, s20, s18
    s_add_u32 s20, s20, 252
    s_cmp_ge_u32 s18, 4
    s_cselect_b32 s20, s20, -1
    s_mul_i32 s21, s95, 4864
    s_mul_i32 s98, s18, 4864
    s_add_u32 s98, s98, 24576
    s_cmp_eq_u32 s45, 7
    s_cselect_b32 s99, s19, s20
    s_cselect_b32 s98, s98, s21
    v_lshrrev_b32 v208, 2, v0
    v_and_b32 v209, 3, v0
    v_mul_u32_u24 v200, 1152, v208
    v_lshlrev_b32 v201, 1, v200
    v_lshl_add_u32 v200, v209, 4, v200
    v_lshl_add_u32 v201, v209, 4, v201
    v_lshlrev_b32 v202, 4, v0
    s_mul_i32 s40, s99, 3641
    s_lshr_b32 s40, s40, 16
    s_mul_i32 s41, s40, 18
    s_sub_u32 s41, s99, s41
    s_waitcnt lgkmcnt(0)
    s_cmp_eq_u32 s99, -1
    s_cbranch_scc1 L_nopi
    s_mov_b32 s24, s8
    s_mov_b32 s25, s9
    s_mov_b32 s26, 2359296
    s_mov_b32 s27, 0x00020000
    s_mov_b32 s28, s10
    s_mov_b32 s29, s11
    s_mov_b32 s30, 2359296
    s_mov_b32 s31, 0x00020000
    s_mov_b32 s32, s12
    s_mov_b32 s33, s13
    s_mov_b32 s34, 4608
    s_mov_b32 s35, 0x00020000
    s_mov_b32 s36, s16
    s_mov_b32 s37, s17
    s_mov_b32 s38, 14196864
    s_mov_b32 s39, 0x00020000
    v_mov_b32 v212, 14196736
    buffer_load_dwordx2 v[214:215], v212, s[36:39], 0 offen sc0 sc1
    s_mul_i32 s22, s40, 36864
    s_lshl_b32 s23, s41, 6
    s_add_u32 s22, s22, s23
    v_add_u32 v203, s22, v200
    v_subrev_u32 v203, 3456, v203
    s_add_u32 m0, s98, 256
    s_add_u32 s23, s22, 0
    buffer_load_dwordx4 v200, s[24:27], s23 offen lds
    s_add_u32 m0, s98, 1280
    s_add_u32 s23, s22, 18432
    buffer_load_dwordx4 v200, s[24:27], s23 offen lds
    buffer_load_dwordx4 v[180:183], v201, s[28:31], s22 offen
    buffer_load_dwordx4 v[184:187], v201, s[28:31], s22 offen offset:1152
    s_add_u32 m0, s98, 64
    s_mov_b32 exec_lo, 0xfff
    s_mov_b32 exec_hi, 0x0
    buffer_load_dwordx4 v203, s[24:27], 0 offen lds
    s_add_u32 m0, s98, 2304
    s_mov_b32 exec_lo, 0xffff
    s_lshl_b32 s23, s41, 8
    buffer_load_dwordx4 v202, s[32:35], s23 offen lds
    s_mov_b64 exec, -1
L_nopi:
    s_barrier
    s_cmp_eq_u32 s45, 7
    s_cbranch_scc1 L_spare
    s_cmp_ge_u32 s18, 4
    s_cbranch_scc1 L_mma
L_ld:
    s_setprio 3
    v_lshrrev_b32 v4, 4, v0
    v_lshlrev_b32 v6, 1, v4
    v_and_b32 v7, 15, v0
    v_xor_b32 v6, v6, v7
    v_mul_u32_u24 v5, 3456, v4
    v_lshl_add_u32 v2, v6, 4, v5
    v_xor_b32 v6, 8, v6
    v_lshl_add_u32 v3, v6, 4, v5
    v_lshrrev_b32 v5, 3, v0
    v_mul_u32_u24 v6, 2304, v5
    v_lshrrev_b32 v5, 1, v5
    v_and_b32 v7, 7, v0
    v_xor_b32 v5, v5, v7
    v_lshl_add_u32 v8, v5, 4, v6
    v_xor_b32 v5, 4, v5
    v_lshl_add_u32 v9, v5, 4, v6
    v_add_u32 v9, 18432, v9
    s_lshr_b32 s46, s2, 3
    s_mul_i32 s19, s46, 57
    s_lshr_b32 s19, s19, 9
    s_mul_i32 s19, s19, 9
    s_sub_u32 s46, s46, s19
    s_mul_i32 s19, s43, 147456
    s_lshl_b32 s20, s44, 8
    s_add_u32 s48, s4, s19
    s_addc_u32 s49, s5, 0
    s_mov_b32 s50, 147456
    s_mov_b32 s51, 0x00020000
    s_add_u32 s52, s6, s20
    s_addc_u32 s53, s7, 0
    s_sub_u32 s54, 1990656, s20
    s_mov_b32 s55, 0x00020000
    s_load_dwordx2 s[28:29], s[0:1], 72
    v_and_b32 v13, 3, v0
    v_bfe_u32 v14, v0, 3, 1
    v_lshl_or_b32 v13, v14, 2, v13
    v_xor_b32 v13, 4, v13
    v_lshlrev_b32 v13, 5, v13
    v_lshl_add_u32 v14, v0, 8, v13
    v_lshlrev_b32 v15, 1, v0
    v_mov_b32 v10, 22016
    v_mov_b32 v11, 1
    s_mov_b32 s36, s16
    s_mov_b32 s37, s17
    s_mov_b32 s38, 14196864
    s_mov_b32 s39, 0x00020000
    s_mov_b32 s58, s18
    s_branch L_ld_go
L_ld_issue:
    s_mov_b64 exec, 1
    ds_add_rtn_u32 v12, v10, v11 offset:28
    s_mov_b64 exec, -1
    s_waitcnt lgkmcnt(0)
    v_readfirstlane_b32 s58, v12
    s_add_u32 s58, s58, 4
    s_cmp_gt_u32 s58, 8
    s_cbranch_scc1 L_ld_done
    s_lshl_b32 s19, s58, 2
    s_add_u32 s19, s19, 22100
    v_mov_b32 v12, s19
    s_mov_b32 s97, 320000
gb_1:
    ds_read_b32 v13, v12
    s_sub_u32 s97, s97, 1
    s_cbranch_scc1 gbd_2
    s_waitcnt lgkmcnt(0)
    v_readfirstlane_b32 s22, v13
    s_cmp_ge_u32 s22, 4
    s_cbranch_scc1 gbd_2
    s_sleep 1
    s_branch gb_1
gbd_2:
    s_waitcnt lgkmcnt(0)
L_ld_go:
    s_add_u32 s59, s46, s58
    s_sub_u32 s19, s59, 9
    s_cmp_ge_u32 s59, 9
    s_cselect_b32 s59, s19, s59
    s_and_b32 s47, s58, 3
    s_lshl_b32 s47, s47, 15
    s_add_u32 s47, s47, 24576
    s_mul_i32 s19, s59, 221184
    s_lshl_b32 s20, s59, 7
    v_mov_b32 v12, 22040
    s_mov_b32 s97, 320000
gb_3:
    ds_read_b32 v13, v12
    s_sub_u32 s97, s97, 1
    s_cbranch_scc1 gbd_4
    s_waitcnt lgkmcnt(0)
    v_readfirstlane_b32 s22, v13
    s_cmp_ge_u32 s22, s58
    s_cbranch_scc1 gbd_4
    s_sleep 1
    s_branch gb_3
gbd_4:
    s_waitcnt lgkmcnt(0)
    s_add_u32 m0, s47, 0
    s_nop 0
    buffer_load_dwordx4 v2, s[52:55], s19 offen lds
    s_add_u32 m0, s47, 16384
    s_add_u32 s19, s19, 13824
    buffer_load_dwordx4 v8, s[48:51], s20 offen lds
    s_add_u32 m0, s47, 1024
    s_nop 0
    buffer_load_dwordx4 v2, s[52:55], s19 offen lds
    s_add_u32 m0, s47, 17408
    s_add_u32 s19, s19, 13824
    buffer_load_dwordx4 v9, s[48:51], s20 offen lds
    s_add_u32 m0, s47, 2048
    s_add_u32 s20, s20, 1152
    buffer_load_dwordx4 v3, s[52:55], s19 offen lds
    s_add_u32 m0, s47, 18432
    s_add_u32 s19, s19, 13824
    buffer_load_dwordx4 v8, s[48:51], s20 offen lds
    s_add_u32 m0, s47, 3072
    s_nop 0
    buffer_load_dwordx4 v3, s[52:55], s19 offen lds
    s_add_u32 m0, s47, 19456
    s_add_u32 s19, s19, 13824
    buffer_load_dwordx4 v9, s[48:51], s20 offen lds
    s_add_u32 m0, s47, 4096
    s_add_u32 s20, s20, 35712
    buffer_load_dwordx4 v2, s[52:55], s19 offen lds
    s_add_u32 m0, s47, 20480
    s_add_u32 s19, s19, 13824
    buffer_load_dwordx4 v8, s[48:51], s20 offen lds
    s_add_u32 m0, s47, 5120
    s_nop 0
    buffer_load_dwordx4 v2, s[52:55], s19 offen lds
    s_add_u32 m0, s47, 21504
    s_add_u32 s19, s19, 13824
    buffer_load_dwordx4 v9, s[48:51], s20 offen lds
    s_add_u32 m0, s47, 6144
    s_add_u32 s20, s20, 1152
    buffer_load_dwordx4 v3, s[52:55], s19 offen lds
    s_add_u32 m0, s47, 22528
    s_add_u32 s19, s19, 13824
    buffer_load_dwordx4 v8, s[48:51], s20 offen lds
    s_add_u32 m0, s47, 7168
    s_nop 0
    buffer_load_dwordx4 v3, s[52:55], s19 offen lds
    s_add_u32 m0, s47, 23552
    s_add_u32 s19, s19, 13824
    buffer_load_dwordx4 v9, s[48:51], s20 offen lds
    s_add_u32 m0, s47, 8192
    s_add_u32 s20, s20, 35712
    buffer_load_dwordx4 v2, s[52:55], s19 offen lds
    s_add_u32 m0, s47, 24576
    s_add_u32 s19, s19, 13824
    buffer_load_dwordx4 v8, s[48:51], s20 offen lds
    s_add_u32 m0, s47, 9216
    s_nop 0
    buffer_load_dwordx4 v2, s[52:55], s19 offen lds
    s_add_u32 m0, s47, 25600
    s_add_u32 s19, s19, 13824
    buffer_load_dwordx4 v9, s[48:51], s20 offen lds
    s_add_u32 m0, s47, 10240
    s_add_u32 s20, s20, 1152
    buffer_load_dwordx4 v3, s[52:55], s19 offen lds
    s_add_u32 m0, s47, 26624
    s_add_u32 s19, s19, 13824
    buffer_load_dwordx4 v8, s[48:51], s20 offen lds
    s_add_u32 m0, s47, 11264
    s_nop 0
    buffer_load_dwordx4 v3, s[52:55], s19 offen lds
    s_add_u32 m0, s47, 27648
    s_add_u32 s19, s19, 13824
    buffer_load_dwordx4 v9, s[48:51], s20 offen lds
    s_add_u32 m0, s47, 12288
    s_add_u32 s20, s20, 35712
    buffer_load_dwordx4 v2, s[52:55], s19 offen lds
    s_add_u32 m0, s47, 28672
    s_add_u32 s19, s19, 13824
    buffer_load_dwordx4 v8, s[48:51], s20 offen lds
    s_add_u32 m0, s47, 13312
    s_nop 0
    buffer_load_dwordx4 v2, s[52:55], s19 offen lds
    s_add_u32 m0, s47, 29696
    s_add_u32 s19, s19, 13824
    buffer_load_dwordx4 v9, s[48:51], s20 offen lds
    s_add_u32 m0, s47, 14336
    s_add_u32 s20, s20, 1152
    buffer_load_dwordx4 v3, s[52:55], s19 offen lds
    s_add_u32 m0, s47, 30720
    s_add_u32 s19, s19, 13824
    buffer_load_dwordx4 v8, s[48:51], s20 offen lds
    s_add_u32 m0, s47, 15360
    s_nop 0
    buffer_load_dwordx4 v3, s[52:55], s19 offen lds
    s_add_u32 m0, s47, 31744
    s_add_u32 s19, s19, 13824
    buffer_load_dwordx4 v9, s[48:51], s20 offen lds
    s_mov_b64 exec, 1
    ds_add_u32 v10, v11 offset:24
    s_mov_b64 exec, -1
    s_cmp_lg_u32 s44, 13
    s_cbranch_scc1 L_ld_ng
    s_mov_b32 s30, 1152
    s_mov_b32 s31, 0x00020000
    s_lshl_b32 s20, s59, 7
    buffer_load_ushort v16, v15, s[28:31], s20 offen
    v_add_u32 v17, s47, v14
    s_waitcnt vmcnt(0)
    ds_write_b16 v17, v16
L_ld_ng:
    s_lshl_b32 s19, s58, 2
    v_add_u32 v12, s19, v10
    s_waitcnt vmcnt(0)
    s_mov_b64 exec, 1
    ds_add_u32 v12, v11 offset:64
    s_mov_b64 exec, -1
    s_branch L_ld_issue
L_ld_done:
    s_setprio 0
    s_cmp_ge_u32 s18, 2
    s_cbranch_scc1 L_aux2
    s_branch L_cvwait
L_aux2:
    v_mov_b32 v20, 22212
    s_mov_b32 s97, 320000
gb_5:
    ds_read_b32 v21, v20
    s_sub_u32 s97, s97, 1
    s_cbranch_scc1 gbd_6
    s_waitcnt lgkmcnt(0)
    v_readfirstlane_b32 s22, v21
    s_cmp_ge_u32 s22, 0x80000000
    s_cbranch_scc1 gbd_6
    s_sleep 1
    s_branch gb_5
gbd_6:
    s_waitcnt lgkmcnt(0)
    v_mov_b32 v20, 22208
    ds_read_b64 v[22:23], v20
    s_waitcnt lgkmcnt(0)
    v_readfirstlane_b32 s88, v22
    v_readfirstlane_b32 s89, v23
    s_and_b32 s46, s18, 1
    v_mov_b32 v4, 22028
    s_mov_b32 s97, 320000
gb_7:
    ds_read_b32 v5, v4
    s_sub_u32 s97, s97, 1
    s_cbranch_scc1 gbd_8
    s_waitcnt lgkmcnt(0)
    v_readfirstlane_b32 s22, v5
    s_cmp_ge_u32 s22, 4
    s_cbranch_scc1 gbd_8
    s_sleep 1
    s_branch gb_7
gbd_8:
    s_waitcnt lgkmcnt(0)
    s_add_u32 s56, s3, s46
    s_lshl_b32 s20, s56, 12
    s_mov_b32 s48, s14
    s_mov_b32 s49, s15
    s_mov_b32 s50, 2359296
    s_mov_b32 s51, 0x00020000
    v_lshlrev_b32 v4, 4, v0
    buffer_load_dwordx4 v[128:131], v4, s[48:51], s20 offen offset:0
    buffer_load_dwordx4 v[132:135], v4, s[48:51], s20 offen offset:1024
    buffer_load_dwordx4 v[136:139], v4, s[48:51], s20 offen offset:2048
    buffer_load_dwordx4 v[140:143], v4, s[48:51], s20 offen offset:3072
    v_mov_b32 v3, 1
    s_lshr_b32 s21, s3, 5
    v_mul_u32_u24 v8, 18, v0
    v_add_u32 v8, s21, v8
    v_and_b32 v9, 31, v8
    v_add_u32 v9, 224, v9
    v_cmp_gt_u32 vcc, 256, v8
    v_subrev_u32 v8, 256, v8
    v_lshrrev_b32 v8, 2, v8
    v_cndmask_b32 v8, v8, v9, vcc
    v_lshlrev_b32 v8, 7, v8
    s_mov_b32 s22, 14163968
    s_mov_b32 s97, 40000
fspin_9:
    buffer_load_dwordx2 v[10:11], v8, s[36:39], s22 offen sc0 sc1
    s_waitcnt vmcnt(0)
    v_cmp_ne_u64 vcc, s[88:89], v[10:11]
    s_cbranch_vccz fdone_10
    s_sleep 6
    s_sub_u32 s97, s97, 1
    s_cbranch_scc0 fspin_9
fdone_10:
    s_mul_i32 s41, s46, 4864
    v_sub_u32 v4, 63, v0
    v_lshlrev_b32 v4, 6, v4
    s_lshl_b32 s21, s56, 12
    s_add_u32 s21, s21, 7077888
    s_mov_b32 s23, s41
    v_lshl_add_u32 v5, v0, 1, s23
    v_mov_b32 v6, 0
    s_add_u32 m0, s23, 0
    ds_write_b16 v5, v6 offset:1024
    buffer_load_dwordx4 v4, s[36:39], s21 offen sc1 lds
    s_add_u32 s21, s21, 16
    s_add_u32 m0, s23, 1216
    ds_write_b16 v5, v6 offset:2240
    buffer_load_dwordx4 v4, s[36:39], s21 offen sc1 lds
    s_add_u32 s21, s21, 16
    s_add_u32 m0, s23, 2432
    ds_write_b16 v5, v6 offset:3456
    buffer_load_dwordx4 v4, s[36:39], s21 offen sc1 lds
    s_add_u32 s21, s21, 16
    s_add_u32 m0, s23, 3648
    ds_write_b16 v5, v6 offset:4672
    buffer_load_dwordx4 v4, s[36:39], s21 offen sc1 lds
    s_add_u32 s21, s21, 16
    v_mov_b32 v6, 0
    v_mov_b32 v7, 0
    s_nop 1
    v_mov_b32_dpp v6, v130 wave_shr:1 row_mask:0xf bank_mask:0xf
    v_mov_b32_dpp v7, v131 wave_shr:1 row_mask:0xf bank_mask:0xf
    v_alignbit_b32 v64, v128, v7, 16
    v_alignbit_b32 v65, v129, v128, 16
    v_alignbit_b32 v66, v130, v129, 16
    v_alignbit_b32 v67, v131, v130, 16
    v_mov_b32 v68, v7
    v_mov_b32 v69, v128
    v_mov_b32 v70, v129
    v_mov_b32 v71, v130
    v_alignbit_b32 v72, v7, v6, 16
    v_mov_b32 v73, v64
    v_mov_b32 v74, v65
    v_mov_b32 v75, v66
    v_mov_b32 v6, 0
    v_mov_b32 v7, 0
    v_readlane_b32 s20, v130, 63
    v_readlane_b32 s21, v131, 63
    s_nop 1
    v_mov_b32 v6, s20
    v_mov_b32 v7, s21
    s_nop 1
    v_mov_b32_dpp v6, v134 wave_shr:1 row_mask:0xf bank_mask:0xf
    v_mov_b32_dpp v7, v135 wave_shr:1 row_mask:0xf bank_mask:0xf
    v_alignbit_b32 v76, v132, v7, 16
    v_alignbit_b32 v77, v133, v132, 16
    v_alignbit_b32 v78, v134, v133, 16
    v_alignbit_b32 v79, v135, v134, 16
    v_mov_b32 v80, v7
    v_mov_b32 v81, v132
    v_mov_b32 v82, v133
    v_mov_b32 v83, v134
    v_alignbit_b32 v84, v7, v6, 16
    v_mov_b32 v85, v76
    v_mov_b32 v86, v77
    v_mov_b32 v87, v78
    v_mov_b32 v6, 0
    v_mov_b32 v7, 0
    v_readlane_b32 s20, v134, 63
    v_readlane_b32 s21, v135, 63
    s_nop 1
    v_mov_b32 v6, s20
    v_mov_b32 v7, s21
    s_nop 1
    v_mov_b32_dpp v6, v138 wave_shr:1 row_mask:0xf bank_mask:0xf
    v_mov_b32_dpp v7, v139 wave_shr:1 row_mask:0xf bank_mask:0xf
    v_alignbit_b32 v88, v136, v7, 16
    v_alignbit_b32 v89, v137, v136, 16
    v_alignbit_b32 v90, v138, v137, 16
    v_alignbit_b32 v91, v139, v138, 16
    v_mov_b32 v92, v7
    v_mov_b32 v93, v136
    v_mov_b32 v94, v137
    v_mov_b32 v95, v138
    v_alignbit_b32 v96, v7, v6, 16
    v_mov_b32 v97, v88
    v_mov_b32 v98, v89
    v_mov_b32 v99, v90
    v_mov_b32 v6, 0
    v_mov_b32 v7, 0
    v_readlane_b32 s20, v138, 63
    v_readlane_b32 s21, v139, 63
    s_nop 1
    v_mov_b32 v6, s20
    v_mov_b32 v7, s21
    s_nop 1
    v_mov_b32_dpp v6, v142 wave_shr:1 row_mask:0xf bank_mask:0xf
    v_mov_b32_dpp v7, v143 wave_shr:1 row_mask:0xf bank_mask:0xf
    v_alignbit_b32 v100, v140, v7, 16
    v_alignbit_b32 v101, v141, v140, 16
    v_alignbit_b32 v102, v142, v141, 16
    v_alignbit_b32 v103, v143, v142, 16
    v_mov_b32 v104, v7
    v_mov_b32 v105, v140
    v_mov_b32 v106, v141
    v_mov_b32 v107, v142
    v_alignbit_b32 v108, v7, v6, 16
    v_mov_b32 v109, v100
    v_mov_b32 v110, v101
    v_mov_b32 v111, v102
    s_lshl_b32 s21, s46, 2
    s_add_u32 s21, s21, 22136
    v_mov_b32 v4, s21
    s_mov_b32 s97, 320000
gb_11:
    ds_read_b32 v5, v4
    s_sub_u32 s97, s97, 1
    s_cbranch_scc1 gbd_12
    s_waitcnt lgkmcnt(0)
    v_readfirstlane_b32 s22, v5
    s_cmp_ge_u32 s22, 4
    s_cbranch_scc1 gbd_12
    s_sleep 1
    s_branch gb_11
gbd_12:
    s_waitcnt lgkmcnt(0)
    s_lshl_b32 s41, s46, 15
    s_add_u32 s41, s41, 57344
    v_lshl_add_u32 v4, v0, 4, s41
    ds_write_b128 v4, v[128:131] offset:32
    ds_write_b128 v4, v[64:67] offset:8224
    ds_write_b128 v4, v[68:71] offset:16416
    ds_write_b128 v4, v[72:75] offset:24608
    ds_write_b128 v4, v[132:135] offset:1056
    ds_write_b128 v4, v[76:79] offset:9248
    ds_write_b128 v4, v[80:83] offset:17440
    ds_write_b128 v4, v[84:87] offset:25632
    ds_write_b128 v4, v[136:139] offset:2080
    ds_write_b128 v4, v[88:91] offset:10272
    ds_write_b128 v4, v[92:95] offset:18464
    ds_write_b128 v4, v[96:99] offset:26656
    ds_write_b128 v4, v[140:143] offset:3104
    ds_write_b128 v4, v[100:103] offset:11296
    ds_write_b128 v4, v[104:107] offset:19488
    ds_write_b128 v4, v[108:111] offset:27680
    v_mov_b32 v6, 0
    v_mov_b32 v7, 0
    v_lshl_add_u32 v4, v0, 3, s41
    s_mov_b32 exec_lo, 0xf
    s_mov_b32 exec_hi, 0x0
    ds_write_b64 v4, v[6:7] offset:0
    ds_write_b64 v4, v[6:7] offset:8192
    ds_write_b64 v4, v[6:7] offset:16384
    ds_write_b64 v4, v[6:7] offset:24576
    s_mov_b64 exec, -1
    s_waitcnt vmcnt(0)
    s_lshl_b32 s21, s46, 2
    s_add_u32 s21, s21, 22032
    v_mov_b32 v4, s21
    ds_write_b32 v4, v3
    s_setprio 0
L_cvwait:
    s_lshl_b32 s21, s90, 2
    s_add_u32 s21, s21, 22032
    v_mov_b32 v1, s21
    s_mov_b32 s97, 320000
gb_13:
    ds_read_b32 v2, v1
    s_sub_u32 s97, s97, 1
    s_cbranch_scc1 gbd_14
    s_waitcnt lgkmcnt(0)
    v_readfirstlane_b32 s22, v2
    s_cmp_ge_u32 s22, 1
    s_cbranch_scc1 gbd_14
    s_sleep 1
    s_branch gb_13
gbd_14:
    s_waitcnt lgkmcnt(0)
    v_mov_b32 v8, 22208
    ds_read_b64 v[10:11], v8
    s_waitcnt lgkmcnt(0)
    v_readfirstlane_b32 s88, v10
    v_readfirstlane_b32 s89, v11
    s_branch L_conv
L_mma:
    s_setprio 1
    s_mov_b32 s36, s16
    s_mov_b32 s37, s17
    s_mov_b32 s38, 14196864
    s_mov_b32 s39, 0x00020000
    s_cmp_eq_u32 s99, -1
    s_cbranch_scc1 L_mnp
    s_waitcnt vmcnt(0)
    v_readfirstlane_b32 s88, v214
    v_readfirstlane_b32 s89, v215
    v_mov_b32 v212, 22208
    s_add_u32 s88, s88, 1
    s_addc_u32 s89, s89, 0
    s_or_b32 s89, s89, 0x80000000
    v_mov_b32 v214, s88
    v_mov_b32 v215, s89
    ds_write_b64 v212, v[214:215]
    v_lshlrev_b32 v200, 7, v208
    v_lshl_add_u32 v200, v209, 4, v200
    v_add_u32 v200, s98, v200
    v_lshl_add_u32 v201, v209, 6, s98
    ds_read_b128 v[116:119], v200 offset:64
    ds_read_b128 v[120:123], v200 offset:128
    ds_read_b128 v[124:127], v200 offset:192
    ds_read_b128 v[128:131], v200 offset:256
    ds_read_b128 v[132:135], v200 offset:320
    ds_read_b128 v[136:139], v201 offset:2304
    ds_read_b128 v[140:143], v201 offset:2320
    ds_read_b128 v[144:147], v201 offset:2336
    ds_read_b128 v[148:151], v201 offset:2352
    s_mov_b32 s42, 0xffff0000
    v_lshrrev_b32 v202, 3, v0
    v_mul_u32_u24 v202, 288, v202
    v_and_b32 v203, 1, v208
    v_lshl_add_u32 v202, v203, 2, v202
    v_add_u32 v202, v202, v201
    v_add_u32 v202, 2560, v202
    v_bfe_u32 v203, v0, 2, 2
    v_sub_u32 v203, 3, v203
    v_mul_u32_u24 v203, 288, v203
    v_lshrrev_b32 v204, 4, v0
    v_lshl_add_u32 v203, v204, 5, v203
    v_lshl_add_u32 v203, v209, 3, v203
    v_add_u32 v203, s98, v203
    v_lshlrev_b32 v204, 12, v208
    v_lshl_add_u32 v204, v209, 4, v204
    s_lshl_b32 s22, s41, 17
    s_lshl_b32 s23, s40, 6
    s_add_u32 s22, s22, s23
    s_add_u32 s22, s22, 7077888
    s_add_u32 s23, s22, 65536
    v_lshlrev_b32 v100, 16, v180
    v_and_b32 v101, s42, v180
    v_lshlrev_b32 v102, 16, v181
    v_and_b32 v103, s42, v181
    v_lshlrev_b32 v104, 16, v184
    v_and_b32 v105, s42, v184
    v_lshlrev_b32 v106, 16, v185
    v_and_b32 v107, s42, v185
    s_waitcnt lgkmcnt(4)
    v_lshlrev_b32 v64, 16, v116
    v_and_b32 v65, s42, v116
    v_lshlrev_b32 v66, 16, v117
    v_and_b32 v67, s42, v117
    v_lshlrev_b32 v68, 16, v120
    v_and_b32 v69, s42, v120
    v_lshlrev_b32 v70, 16, v121
    v_and_b32 v71, s42, v121
    v_lshlrev_b32 v72, 16, v124
    v_and_b32 v73, s42, v124
    v_lshlrev_b32 v74, 16, v125
    v_and_b32 v75, s42, v125
    v_lshlrev_b32 v76, 16, v128
    v_and_b32 v77, s42, v128
    v_lshlrev_b32 v78, 16, v129
    v_and_b32 v79, s42, v129
    v_lshlrev_b32 v80, 16, v132
    v_and_b32 v81, s42, v132
    v_lshlrev_b32 v82, 16, v133
    v_and_b32 v83, s42, v133
    s_waitcnt lgkmcnt(0)
    v_lshlrev_b32 v84, 16, v136
    v_and_b32 v85, s42, v136
    v_lshlrev_b32 v86, 16, v137
    v_and_b32 v87, s42, v137
    v_lshlrev_b32 v88, 16, v138
    v_and_b32 v89, s42, v138
    v_lshlrev_b32 v90, 16, v139
    v_and_b32 v91, s42, v139
    v_lshlrev_b32 v92, 16, v140
    v_and_b32 v93, s42, v140
    v_lshlrev_b32 v94, 16, v141
    v_and_b32 v95, s42, v141
    v_lshlrev_b32 v96, 16, v142
    v_and_b32 v97, s42, v142
    v_lshlrev_b32 v98, 16, v143
    v_and_b32 v99, s42, v143
    v_mul_f32 v108, v64, v87
    v_mul_f32 v109, v65, v91
    v_mul_f32 v110, v66, v95
    v_mul_f32 v111, v67, v99
    v_mul_f32 v112, v68, v87
    v_mul_f32 v113, v69, v91
    v_mul_f32 v114, v70, v95
    v_mul_f32 v115, v71, v99
    v_fmac_f32 v108, v68, v86
    v_fmac_f32 v109, v69, v90
    v_fmac_f32 v110, v70, v94
    v_fmac_f32 v111, v71, v98
    v_fmac_f32 v112, v72, v86
    v_fmac_f32 v113, v73, v90
    v_fmac_f32 v114, v74, v94
    v_fmac_f32 v115, v75, v98
    v_fmac_f32 v108, v72, v85
    v_fmac_f32 v109, v73, v89
    v_fmac_f32 v110, v74, v93
    v_fmac_f32 v111, v75, v97
    v_fmac_f32 v112, v76, v85
    v_fmac_f32 v113, v77, v89
    v_fmac_f32 v114, v78, v93
    v_fmac_f32 v115, v79, v97
    v_fmac_f32 v108, v76, v84
    v_fmac_f32 v109, v77, v88
    v_fmac_f32 v110, v78, v92
    v_fmac_f32 v111, v79, v96
    v_fmac_f32 v112, v80, v84
    v_fmac_f32 v113, v81, v88
    v_fmac_f32 v114, v82, v92
    v_fmac_f32 v115, v83, v96
    v_cvt_pk_bf16_f32 v108, 0, v108
    v_cvt_pk_bf16_f32 v109, 0, v109
    v_cvt_pk_bf16_f32 v110, 0, v110
    v_cvt_pk_bf16_f32 v111, 0, v111
    v_cvt_pk_bf16_f32 v112, 0, v112
    v_cvt_pk_bf16_f32 v113, 0, v113
    v_cvt_pk_bf16_f32 v114, 0, v114
    v_cvt_pk_bf16_f32 v115, 0, v115
    v_mul_f32 v108, v108, v100
    v_mul_f32 v109, v109, v101
    v_mul_f32 v110, v110, v102
    v_mul_f32 v111, v111, v103
    v_mul_f32 v112, v112, v104
    v_mul_f32 v113, v113, v105
    v_mul_f32 v114, v114, v106
    v_mul_f32 v115, v115, v107
    v_cvt_pk_bf16_f32 v152, v108, v112
    v_cvt_pk_bf16_f32 v153, v109, v113
    v_cvt_pk_bf16_f32 v154, v110, v114
    v_cvt_pk_bf16_f32 v155, v111, v115
    ds_write2_b32 v202, v152, v153 offset0:0 offset1:2
    ds_write2_b32 v202, v154, v155 offset0:4 offset1:6
    v_lshlrev_b32 v100, 16, v182
    v_and_b32 v101, s42, v182
    v_lshlrev_b32 v102, 16, v183
    v_and_b32 v103, s42, v183
    v_lshlrev_b32 v104, 16, v186
    v_and_b32 v105, s42, v186
    v_lshlrev_b32 v106, 16, v187
    v_and_b32 v107, s42, v187
    v_lshlrev_b32 v64, 16, v118
    v_and_b32 v65, s42, v118
    v_lshlrev_b32 v66, 16, v119
    v_and_b32 v67, s42, v119
    v_lshlrev_b32 v68, 16, v122
    v_and_b32 v69, s42, v122
    v_lshlrev_b32 v70, 16, v123
    v_and_b32 v71, s42, v123
    v_lshlrev_b32 v72, 16, v126
    v_and_b32 v73, s42, v126
    v_lshlrev_b32 v74, 16, v127
    v_and_b32 v75, s42, v127
    v_lshlrev_b32 v76, 16, v130
    v_and_b32 v77, s42, v130
    v_lshlrev_b32 v78, 16, v131
    v_and_b32 v79, s42, v131
    v_lshlrev_b32 v80, 16, v134
    v_and_b32 v81, s42, v134
    v_lshlrev_b32 v82, 16, v135
    v_and_b32 v83, s42, v135
    v_lshlrev_b32 v84, 16, v144
    v_and_b32 v85, s42, v144
    v_lshlrev_b32 v86, 16, v145
    v_and_b32 v87, s42, v145
    v_lshlrev_b32 v88, 16, v146
    v_and_b32 v89, s42, v146
    v_lshlrev_b32 v90, 16, v147
    v_and_b32 v91, s42, v147
    v_lshlrev_b32 v92, 16, v148
    v_and_b32 v93, s42, v148
    v_lshlrev_b32 v94, 16, v149
    v_and_b32 v95, s42, v149
    v_lshlrev_b32 v96, 16, v150
    v_and_b32 v97, s42, v150
    v_lshlrev_b32 v98, 16, v151
    v_and_b32 v99, s42, v151
    v_mul_f32 v108, v64, v87
    v_mul_f32 v109, v65, v91
    v_mul_f32 v110, v66, v95
    v_mul_f32 v111, v67, v99
    v_mul_f32 v112, v68, v87
    v_mul_f32 v113, v69, v91
    v_mul_f32 v114, v70, v95
    v_mul_f32 v115, v71, v99
    v_fmac_f32 v108, v68, v86
    v_fmac_f32 v109, v69, v90
    v_fmac_f32 v110, v70, v94
    v_fmac_f32 v111, v71, v98
    v_fmac_f32 v112, v72, v86
    v_fmac_f32 v113, v73, v90
    v_fmac_f32 v114, v74, v94
    v_fmac_f32 v115, v75, v98
    v_fmac_f32 v108, v72, v85
    v_fmac_f32 v109, v73, v89
    v_fmac_f32 v110, v74, v93
    v_fmac_f32 v111, v75, v97
    v_fmac_f32 v112, v76, v85
    v_fmac_f32 v113, v77, v89
    v_fmac_f32 v114, v78, v93
    v_fmac_f32 v115, v79, v97
    v_fmac_f32 v108, v76, v84
    v_fmac_f32 v109, v77, v88
    v_fmac_f32 v110, v78, v92
    v_fmac_f32 v111, v79, v96
    v_fmac_f32 v112, v80, v84
    v_fmac_f32 v113, v81, v88
    v_fmac_f32 v114, v82, v92
    v_fmac_f32 v115, v83, v96
    v_cvt_pk_bf16_f32 v108, 0, v108
    v_cvt_pk_bf16_f32 v109, 0, v109
    v_cvt_pk_bf16_f32 v110, 0, v110
    v_cvt_pk_bf16_f32 v111, 0, v111
    v_cvt_pk_bf16_f32 v112, 0, v112
    v_cvt_pk_bf16_f32 v113, 0, v113
    v_cvt_pk_bf16_f32 v114, 0, v114
    v_cvt_pk_bf16_f32 v115, 0, v115
    v_mul_f32 v108, v108, v100
    v_mul_f32 v109, v109, v101
    v_mul_f32 v110, v110, v102
    v_mul_f32 v111, v111, v103
    v_mul_f32 v112, v112, v104
    v_mul_f32 v113, v113, v105
    v_mul_f32 v114, v114, v106
    v_mul_f32 v115, v115, v107
    v_cvt_pk_bf16_f32 v156, v108, v112
    v_cvt_pk_bf16_f32 v157, v109, v113
    v_cvt_pk_bf16_f32 v158, v110, v114
    v_cvt_pk_bf16_f32 v159, v111, v115
    ds_write2_b32 v202, v156, v157 offset0:8 offset1:10
    ds_write2_b32 v202, v158, v159 offset0:12 offset1:14
    ds_read_b64_tr_b16 v[64:65], v203 offset:3712
    ds_read_b64_tr_b16 v[66:67], v203 offset:2560
    ds_read_b64_tr_b16 v[68:69], v203 offset:3840
    ds_read_b64_tr_b16 v[70:71], v203 offset:2688
    s_waitcnt lgkmcnt(2)
    buffer_store_dwordx4 v[64:67], v204, s[36:39], s22 offen sc1
    s_waitcnt lgkmcnt(0)
    buffer_store_dwordx4 v[68:71], v204, s[36:39], s23 offen sc1
L_mnp:
    v_lshrrev_b32 v12, 4, v0
    v_bfe_u32 v13, v0, 2, 2
    v_and_b32 v14, 1, v12
    v_lshl_or_b32 v14, v14, 2, v13
    s_and_b32 s22, s18, 1
    s_lshl_b32 s22, s22, 2
    v_xor_b32 v14, s22, v14
    v_lshl_add_u32 v15, v12, 3, v13
    v_lshlrev_b32 v15, 8, v15
    v_lshl_add_u32 v15, v14, 5, v15
    v_and_b32 v14, 3, v0
    v_lshl_add_u32 v15, v14, 3, v15
    v_add_u32 v2, 24576, v15
    v_xor_b32 v3, 32, v2
    v_xor_b32 v4, 64, v2
    v_xor_b32 v5, 96, v2
    v_add_u32 v6, 0x10000, v2
    v_add_u32 v7, 0x10000, v3
    v_add_u32 v8, 0x10000, v4
    v_add_u32 v9, 0x10000, v5
    v_and_b32 v13, 15, v0
    s_lshl_b32 s21, s44, 5
    s_lshl_b32 s22, s22, 2
    s_add_u32 s56, s21, s22
    v_add_u32 v14, s56, v12
    v_lshlrev_b32 v14, 14, v14
    s_bfe_u32 s23, s18, 0x10001
    s_lshl_b32 s21, s43, 10
    s_lshl_b32 s22, s23, 9
    s_add_u32 s21, s21, s22
    v_lshl_add_u32 v14, v13, 4, v14
    v_add_u32 v1, s21, v14
    v_lshrrev_b32 v14, 1, v13
    v_xor_b32 v14, v14, v12
    s_lshl_b32 s21, s23, 13
    s_add_u32 s21, s21, 40960
    v_lshlrev_b32 v15, 7, v13
    v_lshl_add_u32 v15, v14, 4, v15
    v_add_u32 v10, s21, v15
    v_xor_b32 v11, 64, v10
    v_add_u32 v12, 0x10000, v10
    v_add_u32 v13, 0x10000, v11
    s_waitcnt lgkmcnt(0)
    s_mov_b32 s48, s16
    s_mov_b32 s49, s17
    s_mov_b32 s50, 7077888
    s_mov_b32 s51, 0x00020000
    s_mov_b32 s36, s16
    s_mov_b32 s37, s17
    s_mov_b32 s38, 14196864
    s_mov_b32 s39, 0x00020000
    v_mov_b32 v208, 22016
    v_mov_b32 v209, 1
    ds_read_b32 v210, v208 offset:64
    s_waitcnt lgkmcnt(0)
    v_readfirstlane_b32 s22, v210
    s_cmp_ge_u32 s22, 1
    s_cbranch_scc1 full_15
    v_add_u32 v210, 64, v208
    s_mov_b32 s97, 320000
gb_16:
    ds_read_b32 v211, v210
    s_sub_u32 s97, s97, 1
    s_cbranch_scc1 gbd_17
    s_waitcnt lgkmcnt(0)
    v_readfirstlane_b32 s22, v211
    s_cmp_ge_u32 s22, 1
    s_cbranch_scc1 gbd_17
    s_sleep 1
    s_branch gb_16
gbd_17:
    s_waitcnt lgkmcnt(0)
full_15:
    ds_read_b64_tr_b16 v[80:81], v2 offset:0
    ds_read_b64_tr_b16 v[82:83], v2 offset:1024
    ds_read_b128 v[112:115], v10 offset:0
    ds_read_b64_tr_b16 v[84:85], v3 offset:0
    ds_read_b64_tr_b16 v[86:87], v3 offset:1024
    ds_read_b128 v[116:119], v10 offset:2048
    ds_read_b64_tr_b16 v[88:89], v4 offset:0
    ds_read_b64_tr_b16 v[90:91], v4 offset:1024
    ds_read_b128 v[120:123], v10 offset:4096
    ds_read_b64_tr_b16 v[92:93], v5 offset:0
    ds_read_b64_tr_b16 v[94:95], v5 offset:1024
    ds_read_b128 v[124:127], v10 offset:6144
    ds_read_b64_tr_b16 v[96:97], v2 offset:8192
    ds_read_b64_tr_b16 v[98:99], v2 offset:9216
    ds_read_b128 v[128:131], v11 offset:0
    ds_read_b64_tr_b16 v[100:101], v3 offset:8192
    ds_read_b64_tr_b16 v[102:103], v3 offset:9216
    ds_read_b128 v[132:135], v11 offset:2048
    ds_read_b64_tr_b16 v[104:105], v4 offset:8192
    ds_read_b64_tr_b16 v[106:107], v4 offset:9216
    ds_read_b128 v[136:139], v11 offset:4096
    ds_read_b64_tr_b16 v[108:109], v5 offset:8192
    ds_read_b64_tr_b16 v[110:111], v5 offset:9216
    ds_read_b128 v[140:143], v11 offset:6144
    s_waitcnt lgkmcnt(0)
    s_mov_b64 exec, 1
    ds_add_u32 v208, v209 offset:100
    s_mov_b64 exec, -1
    ds_read_b32 v210, v208 offset:68
    s_waitcnt lgkmcnt(0)
    v_readfirstlane_b32 s22, v210
    s_cmp_ge_u32 s22, 1
    s_cbranch_scc1 full_18
    v_add_u32 v210, 68, v208
    s_mov_b32 s97, 320000
gb_19:
    ds_read_b32 v211, v210
    s_sub_u32 s97, s97, 1
    s_cbranch_scc1 gbd_20
    s_waitcnt lgkmcnt(0)
    v_readfirstlane_b32 s22, v211
    s_cmp_ge_u32 s22, 1
    s_cbranch_scc1 gbd_20
    s_sleep 1
    s_branch gb_19
gbd_20:
    s_waitcnt lgkmcnt(0)
full_18:
    v_mfma_f32_16x16x32_bf16 v[16:19], v[80:83], v[112:115], 0
    ds_read_b64_tr_b16 v[144:145], v2 offset:32768
    ds_read_b64_tr_b16 v[146:147], v2 offset:33792
    v_mfma_f32_16x16x32_bf16 v[32:35], v[84:87], v[112:115], 0
    ds_read_b128 v[176:179], v10 offset:32768
    ds_read_b64_tr_b16 v[148:149], v3 offset:32768
    v_mfma_f32_16x16x32_bf16 v[48:51], v[88:91], v[112:115], 0
    ds_read_b64_tr_b16 v[150:151], v3 offset:33792
    ds_read_b128 v[180:183], v10 offset:34816
    v_mfma_f32_16x16x32_bf16 v[64:67], v[92:95], v[112:115], 0
    ds_read_b64_tr_b16 v[152:153], v4 offset:32768
    ds_read_b64_tr_b16 v[154:155], v4 offset:33792
    v_mfma_f32_16x16x32_bf16 v[20:23], v[80:83], v[116:119], 0
    ds_read_b128 v[184:187], v10 offset:36864
    ds_read_b64_tr_b16 v[156:157], v5 offset:32768
    v_mfma_f32_16x16x32_bf16 v[36:39], v[84:87], v[116:119], 0
    ds_read_b64_tr_b16 v[158:159], v5 offset:33792
    ds_read_b128 v[188:191], v10 offset:38912
    v_mfma_f32_16x16x32_bf16 v[52:55], v[88:91], v[116:119], 0
    ds_read_b64_tr_b16 v[160:161], v2 offset:40960
    ds_read_b64_tr_b16 v[162:163], v2 offset:41984
    v_mfma_f32_16x16x32_bf16 v[68:71], v[92:95], v[116:119], 0
    ds_read_b128 v[192:195], v11 offset:32768
    ds_read_b64_tr_b16 v[164:165], v3 offset:40960
    v_mfma_f32_16x16x32_bf16 v[24:27], v[80:83], v[120:123], 0
    ds_read_b64_tr_b16 v[166:167], v3 offset:41984
    ds_read_b128 v[196:199], v11 offset:34816
    v_mfma_f32_16x16x32_bf16 v[40:43], v[84:87], v[120:123], 0
    ds_read_b64_tr_b16 v[168:169], v4 offset:40960
    ds_read_b64_tr_b16 v[170:171], v4 offset:41984
    v_mfma_f32_16x16x32_bf16 v[56:59], v[88:91], v[120:123], 0
    ds_read_b128 v[200:203], v11 offset:36864
    ds_read_b64_tr_b16 v[172:173], v5 offset:40960
    v_mfma_f32_16x16x32_bf16 v[72:75], v[92:95], v[120:123], 0
    ds_read_b64_tr_b16 v[174:175], v5 offset:41984
    ds_read_b128 v[204:207], v11 offset:38912
    v_mfma_f32_16x16x32_bf16 v[28:31], v[80:83], v[124:127], 0
    v_mfma_f32_16x16x32_bf16 v[44:47], v[84:87], v[124:127], 0
    v_mfma_f32_16x16x32_bf16 v[60:63], v[88:91], v[124:127], 0
    v_mfma_f32_16x16x32_bf16 v[76:79], v[92:95], v[124:127], 0
    v_mfma_f32_16x16x32_bf16 v[16:19], v[96:99], v[128:131], v[16:19]
    v_mfma_f32_16x16x32_bf16 v[32:35], v[100:103], v[128:131], v[32:35]
    s_waitcnt lgkmcnt(0)
    s_mov_b64 exec, 1
    ds_add_u32 v208, v209 offset:104
    s_mov_b64 exec, -1
    v_mfma_f32_16x16x32_bf16 v[48:51], v[104:107], v[128:131], v[48:51]
    v_mfma_f32_16x16x32_bf16 v[64:67], v[108:111], v[128:131], v[64:67]
    v_mfma_f32_16x16x32_bf16 v[20:23], v[96:99], v[132:135], v[20:23]
    v_mfma_f32_16x16x32_bf16 v[36:39], v[100:103], v[132:135], v[36:39]
    v_mfma_f32_16x16x32_bf16 v[52:55], v[104:107], v[132:135], v[52:55]
    v_mfma_f32_16x16x32_bf16 v[68:71], v[108:111], v[132:135], v[68:71]
    v_mfma_f32_16x16x32_bf16 v[24:27], v[96:99], v[136:139], v[24:27]
    v_mfma_f32_16x16x32_bf16 v[40:43], v[100:103], v[136:139], v[40:43]
    v_mfma_f32_16x16x32_bf16 v[56:59], v[104:107], v[136:139], v[56:59]
    ds_read_b32 v210, v208 offset:72
    v_mfma_f32_16x16x32_bf16 v[72:75], v[108:111], v[136:139], v[72:75]
    v_mfma_f32_16x16x32_bf16 v[28:31], v[96:99], v[140:143], v[28:31]
    v_mfma_f32_16x16x32_bf16 v[44:47], v[100:103], v[140:143], v[44:47]
    v_mfma_f32_16x16x32_bf16 v[60:63], v[104:107], v[140:143], v[60:63]
    v_mfma_f32_16x16x32_bf16 v[76:79], v[108:111], v[140:143], v[76:79]
    s_waitcnt lgkmcnt(0)
    v_readfirstlane_b32 s22, v210
    s_cmp_ge_u32 s22, 1
    s_cbranch_scc1 full_21
    v_add_u32 v210, 72, v208
    s_mov_b32 s97, 320000
gb_22:
    ds_read_b32 v211, v210
    s_sub_u32 s97, s97, 1
    s_cbranch_scc1 gbd_23
    s_waitcnt lgkmcnt(0)
    v_readfirstlane_b32 s22, v211
    s_cmp_ge_u32 s22, 1
    s_cbranch_scc1 gbd_23
    s_sleep 1
    s_branch gb_22
gbd_23:
    s_waitcnt lgkmcnt(0)
full_21:
    s_cmp_eq_u32 s99, -1
    s_cbranch_scc1 L_nf1
    s_waitcnt vmcnt(0)
    s_mov_b64 exec, 1
    ds_add_rtn_u32 v212, v208, v209 offset:12
    s_mov_b64 exec, -1
    s_waitcnt lgkmcnt(0)
    v_readfirstlane_b32 s22, v212
    s_cmp_lg_u32 s22, 3
    s_cbranch_scc1 L_nf1
    s_lshl_b32 s22, s2, 7
    s_add_u32 s22, s22, 14163968
    v_mov_b32 v212, s22
    v_mov_b32 v214, s88
    v_mov_b32 v215, s89
    s_mov_b64 exec, 1
    buffer_store_dwordx2 v[214:215], v212, s[36:39], 0 offen sc0 sc1
    s_mov_b64 exec, -1
L_nf1:
    v_mfma_f32_16x16x32_bf16 v[16:19], v[144:147], v[176:179], v[16:19]
    ds_read_b64_tr_b16 v[80:81], v6 offset:0
    ds_read_b64_tr_b16 v[82:83], v6 offset:1024
    v_mfma_f32_16x16x32_bf16 v[32:35], v[148:151], v[176:179], v[32:35]
    ds_read_b128 v[112:115], v12 offset:0
    ds_read_b64_tr_b16 v[84:85], v7 offset:0
    v_mfma_f32_16x16x32_bf16 v[48:51], v[152:155], v[176:179], v[48:51]
    ds_read_b64_tr_b16 v[86:87], v7 offset:1024
    ds_read_b128 v[116:119], v12 offset:2048
    v_mfma_f32_16x16x32_bf16 v[64:67], v[156:159], v[176:179], v[64:67]
    ds_read_b64_tr_b16 v[88:89], v8 offset:0
    ds_read_b64_tr_b16 v[90:91], v8 offset:1024
    v_mfma_f32_16x16x32_bf16 v[20:23], v[144:147], v[180:183], v[20:23]
    ds_read_b128 v[120:123], v12 offset:4096
    ds_read_b64_tr_b16 v[92:93], v9 offset:0
    v_mfma_f32_16x16x32_bf16 v[36:39], v[148:151], v[180:183], v[36:39]
    ds_read_b64_tr_b16 v[94:95], v9 offset:1024
    ds_read_b128 v[124:127], v12 offset:6144
    v_mfma_f32_16x16x32_bf16 v[52:55], v[152:155], v[180:183], v[52:55]
    ds_read_b64_tr_b16 v[96:97], v6 offset:8192
    ds_read_b64_tr_b16 v[98:99], v6 offset:9216
    v_mfma_f32_16x16x32_bf16 v[68:71], v[156:159], v[180:183], v[68:71]
    ds_read_b128 v[128:131], v13 offset:0
    ds_read_b64_tr_b16 v[100:101], v7 offset:8192
    v_mfma_f32_16x16x32_bf16 v[24:27], v[144:147], v[184:187], v[24:27]
    ds_read_b64_tr_b16 v[102:103], v7 offset:9216
    ds_read_b128 v[132:135], v13 offset:2048
    v_mfma_f32_16x16x32_bf16 v[40:43], v[148:151], v[184:187], v[40:43]
    ds_read_b64_tr_b16 v[104:105], v8 offset:8192
    ds_read_b64_tr_b16 v[106:107], v8 offset:9216
    v_mfma_f32_16x16x32_bf16 v[56:59], v[152:155], v[184:187], v[56:59]
    ds_read_b128 v[136:139], v13 offset:4096
    ds_read_b64_tr_b16 v[108:109], v9 offset:8192
    v_mfma_f32_16x16x32_bf16 v[72:75], v[156:159], v[184:187], v[72:75]
    ds_read_b64_tr_b16 v[110:111], v9 offset:9216
    ds_read_b128 v[140:143], v13 offset:6144
    v_mfma_f32_16x16x32_bf16 v[28:31], v[144:147], v[188:191], v[28:31]
    v_mfma_f32_16x16x32_bf16 v[44:47], v[148:151], v[188:191], v[44:47]
    v_mfma_f32_16x16x32_bf16 v[60:63], v[152:155], v[188:191], v[60:63]
    v_mfma_f32_16x16x32_bf16 v[76:79], v[156:159], v[188:191], v[76:79]
    v_mfma_f32_16x16x32_bf16 v[16:19], v[160:163], v[192:195], v[16:19]
    v_mfma_f32_16x16x32_bf16 v[32:35], v[164:167], v[192:195], v[32:35]
    s_waitcnt lgkmcnt(0)
    s_mov_b64 exec, 1
    ds_add_u32 v208, v209 offset:108
    s_mov_b64 exec, -1
    v_mfma_f32_16x16x32_bf16 v[48:51], v[168:171], v[192:195], v[48:51]
    v_mfma_f32_16x16x32_bf16 v[64:67], v[172:175], v[192:195], v[64:67]
    v_mfma_f32_16x16x32_bf16 v[20:23], v[160:163], v[196:199], v[20:23]
    v_mfma_f32_16x16x32_bf16 v[36:39], v[164:167], v[196:199], v[36:39]
    v_mfma_f32_16x16x32_bf16 v[52:55], v[168:171], v[196:199], v[52:55]
    v_mfma_f32_16x16x32_bf16 v[68:71], v[172:175], v[196:199], v[68:71]
    v_mfma_f32_16x16x32_bf16 v[24:27], v[160:163], v[200:203], v[24:27]
    v_mfma_f32_16x16x32_bf16 v[40:43], v[164:167], v[200:203], v[40:43]
    v_mfma_f32_16x16x32_bf16 v[56:59], v[168:171], v[200:203], v[56:59]
    ds_read_b32 v210, v208 offset:76
    v_mfma_f32_16x16x32_bf16 v[72:75], v[172:175], v[200:203], v[72:75]
    v_mfma_f32_16x16x32_bf16 v[28:31], v[160:163], v[204:207], v[28:31]
    v_mfma_f32_16x16x32_bf16 v[44:47], v[164:167], v[204:207], v[44:47]
    v_mfma_f32_16x16x32_bf16 v[60:63], v[168:171], v[204:207], v[60:63]
    v_mfma_f32_16x16x32_bf16 v[76:79], v[172:175], v[204:207], v[76:79]
    s_waitcnt lgkmcnt(0)
    v_readfirstlane_b32 s22, v210
    s_cmp_ge_u32 s22, 1
    s_cbranch_scc1 full_24
    v_add_u32 v210, 76, v208
    s_mov_b32 s97, 320000
gb_25:
    ds_read_b32 v211, v210
    s_sub_u32 s97, s97, 1
    s_cbranch_scc1 gbd_26
    s_waitcnt lgkmcnt(0)
    v_readfirstlane_b32 s22, v211
    s_cmp_ge_u32 s22, 1
    s_cbranch_scc1 gbd_26
    s_sleep 1
    s_branch gb_25
gbd_26:
    s_waitcnt lgkmcnt(0)
full_24:
    v_mfma_f32_16x16x32_bf16 v[16:19], v[80:83], v[112:115], v[16:19]
    ds_read_b64_tr_b16 v[144:145], v6 offset:32768
    ds_read_b64_tr_b16 v[146:147], v6 offset:33792
    v_mfma_f32_16x16x32_bf16 v[32:35], v[84:87], v[112:115], v[32:35]
    ds_read_b128 v[176:179], v12 offset:32768
    ds_read_b64_tr_b16 v[148:149], v7 offset:32768
    v_mfma_f32_16x16x32_bf16 v[48:51], v[88:91], v[112:115], v[48:51]
    ds_read_b64_tr_b16 v[150:151], v7 offset:33792
    ds_read_b128 v[180:183], v12 offset:34816
    v_mfma_f32_16x16x32_bf16 v[64:67], v[92:95], v[112:115], v[64:67]
    ds_read_b64_tr_b16 v[152:153], v8 offset:32768
    ds_read_b64_tr_b16 v[154:155], v8 offset:33792
    v_mfma_f32_16x16x32_bf16 v[20:23], v[80:83], v[116:119], v[20:23]
    ds_read_b128 v[184:187], v12 offset:36864
    ds_read_b64_tr_b16 v[156:157], v9 offset:32768
    v_mfma_f32_16x16x32_bf16 v[36:39], v[84:87], v[116:119], v[36:39]
    ds_read_b64_tr_b16 v[158:159], v9 offset:33792
    ds_read_b128 v[188:191], v12 offset:38912
    v_mfma_f32_16x16x32_bf16 v[52:55], v[88:91], v[116:119], v[52:55]
    ds_read_b64_tr_b16 v[160:161], v6 offset:40960
    ds_read_b64_tr_b16 v[162:163], v6 offset:41984
    v_mfma_f32_16x16x32_bf16 v[68:71], v[92:95], v[116:119], v[68:71]
    ds_read_b128 v[192:195], v13 offset:32768
    ds_read_b64_tr_b16 v[164:165], v7 offset:40960
    v_mfma_f32_16x16x32_bf16 v[24:27], v[80:83], v[120:123], v[24:27]
    ds_read_b64_tr_b16 v[166:167], v7 offset:41984
    ds_read_b128 v[196:199], v13 offset:34816
    v_mfma_f32_16x16x32_bf16 v[40:43], v[84:87], v[120:123], v[40:43]
    ds_read_b64_tr_b16 v[168:169], v8 offset:40960
    ds_read_b64_tr_b16 v[170:171], v8 offset:41984
    v_mfma_f32_16x16x32_bf16 v[56:59], v[88:91], v[120:123], v[56:59]
    ds_read_b128 v[200:203], v13 offset:36864
    ds_read_b64_tr_b16 v[172:173], v9 offset:40960
    v_mfma_f32_16x16x32_bf16 v[72:75], v[92:95], v[120:123], v[72:75]
    ds_read_b64_tr_b16 v[174:175], v9 offset:41984
    ds_read_b128 v[204:207], v13 offset:38912
    v_mfma_f32_16x16x32_bf16 v[28:31], v[80:83], v[124:127], v[28:31]
    v_mfma_f32_16x16x32_bf16 v[44:47], v[84:87], v[124:127], v[44:47]
    v_mfma_f32_16x16x32_bf16 v[60:63], v[88:91], v[124:127], v[60:63]
    v_mfma_f32_16x16x32_bf16 v[76:79], v[92:95], v[124:127], v[76:79]
    v_mfma_f32_16x16x32_bf16 v[16:19], v[96:99], v[128:131], v[16:19]
    v_mfma_f32_16x16x32_bf16 v[32:35], v[100:103], v[128:131], v[32:35]
    s_waitcnt lgkmcnt(0)
    s_mov_b64 exec, 1
    ds_add_u32 v208, v209 offset:112
    s_mov_b64 exec, -1
    v_mfma_f32_16x16x32_bf16 v[48:51], v[104:107], v[128:131], v[48:51]
    v_mfma_f32_16x16x32_bf16 v[64:67], v[108:111], v[128:131], v[64:67]
    v_mfma_f32_16x16x32_bf16 v[20:23], v[96:99], v[132:135], v[20:23]
    v_mfma_f32_16x16x32_bf16 v[36:39], v[100:103], v[132:135], v[36:39]
    v_mfma_f32_16x16x32_bf16 v[52:55], v[104:107], v[132:135], v[52:55]
    v_mfma_f32_16x16x32_bf16 v[68:71], v[108:111], v[132:135], v[68:71]
    v_mfma_f32_16x16x32_bf16 v[24:27], v[96:99], v[136:139], v[24:27]
    v_mfma_f32_16x16x32_bf16 v[40:43], v[100:103], v[136:139], v[40:43]
    v_mfma_f32_16x16x32_bf16 v[56:59], v[104:107], v[136:139], v[56:59]
    ds_read_b32 v210, v208 offset:80
    v_mfma_f32_16x16x32_bf16 v[72:75], v[108:111], v[136:139], v[72:75]
    v_mfma_f32_16x16x32_bf16 v[28:31], v[96:99], v[140:143], v[28:31]
    v_mfma_f32_16x16x32_bf16 v[44:47], v[100:103], v[140:143], v[44:47]
    v_mfma_f32_16x16x32_bf16 v[60:63], v[104:107], v[140:143], v[60:63]
    v_mfma_f32_16x16x32_bf16 v[76:79], v[108:111], v[140:143], v[76:79]
    s_waitcnt lgkmcnt(0)
    v_readfirstlane_b32 s22, v210
    s_cmp_ge_u32 s22, 1
    s_cbranch_scc1 full_27
    v_add_u32 v210, 80, v208
    s_mov_b32 s97, 320000
gb_28:
    ds_read_b32 v211, v210
    s_sub_u32 s97, s97, 1
    s_cbranch_scc1 gbd_29
    s_waitcnt lgkmcnt(0)
    v_readfirstlane_b32 s22, v211
    s_cmp_ge_u32 s22, 1
    s_cbranch_scc1 gbd_29
    s_sleep 1
    s_branch gb_28
gbd_29:
    s_waitcnt lgkmcnt(0)
full_27:
    v_mfma_f32_16x16x32_bf16 v[16:19], v[144:147], v[176:179], v[16:19]
    ds_read_b64_tr_b16 v[80:81], v2 offset:0
    ds_read_b64_tr_b16 v[82:83], v2 offset:1024
    v_mfma_f32_16x16x32_bf16 v[32:35], v[148:151], v[176:179], v[32:35]
    ds_read_b128 v[112:115], v10 offset:0
    ds_read_b64_tr_b16 v[84:85], v3 offset:0
    v_mfma_f32_16x16x32_bf16 v[48:51], v[152:155], v[176:179], v[48:51]
    ds_read_b64_tr_b16 v[86:87], v3 offset:1024
    ds_read_b128 v[116:119], v10 offset:2048
    v_mfma_f32_16x16x32_bf16 v[64:67], v[156:159], v[176:179], v[64:67]
    ds_read_b64_tr_b16 v[88:89], v4 offset:0
    ds_read_b64_tr_b16 v[90:91], v4 offset:1024
    v_mfma_f32_16x16x32_bf16 v[20:23], v[144:147], v[180:183], v[20:23]
    ds_read_b128 v[120:123], v10 offset:4096
    ds_read_b64_tr_b16 v[92:93], v5 offset:0
    v_mfma_f32_16x16x32_bf16 v[36:39], v[148:151], v[180:183], v[36:39]
    ds_read_b64_tr_b16 v[94:95], v5 offset:1024
    ds_read_b128 v[124:127], v10 offset:6144
    v_mfma_f32_16x16x32_bf16 v[52:55], v[152:155], v[180:183], v[52:55]
    ds_read_b64_tr_b16 v[96:97], v2 offset:8192
    ds_read_b64_tr_b16 v[98:99], v2 offset:9216
    v_mfma_f32_16x16x32_bf16 v[68:71], v[156:159], v[180:183], v[68:71]
    ds_read_b128 v[128:131], v11 offset:0
    ds_read_b64_tr_b16 v[100:101], v3 offset:8192
    v_mfma_f32_16x16x32_bf16 v[24:27], v[144:147], v[184:187], v[24:27]
    ds_read_b64_tr_b16 v[102:103], v3 offset:9216
    ds_read_b128 v[132:135], v11 offset:2048
    v_mfma_f32_16x16x32_bf16 v[40:43], v[148:151], v[184:187], v[40:43]
    ds_read_b64_tr_b16 v[104:105], v4 offset:8192
    ds_read_b64_tr_b16 v[106:107], v4 offset:9216
    v_mfma_f32_16x16x32_bf16 v[56:59], v[152:155], v[184:187], v[56:59]
    ds_read_b128 v[136:139], v11 offset:4096
    ds_read_b64_tr_b16 v[108:109], v5 offset:8192
    v_mfma_f32_16x16x32_bf16 v[72:75], v[156:159], v[184:187], v[72:75]
    ds_read_b64_tr_b16 v[110:111], v5 offset:9216
    ds_read_b128 v[140:143], v11 offset:6144
    v_mfma_f32_16x16x32_bf16 v[28:31], v[144:147], v[188:191], v[28:31]
    v_mfma_f32_16x16x32_bf16 v[44:47], v[148:151], v[188:191], v[44:47]
    v_mfma_f32_16x16x32_bf16 v[60:63], v[152:155], v[188:191], v[60:63]
    v_mfma_f32_16x16x32_bf16 v[76:79], v[156:159], v[188:191], v[76:79]
    v_mfma_f32_16x16x32_bf16 v[16:19], v[160:163], v[192:195], v[16:19]
    v_mfma_f32_16x16x32_bf16 v[32:35], v[164:167], v[192:195], v[32:35]
    s_waitcnt lgkmcnt(0)
    s_mov_b64 exec, 1
    ds_add_u32 v208, v209 offset:116
    s_mov_b64 exec, -1
    v_mfma_f32_16x16x32_bf16 v[48:51], v[168:171], v[192:195], v[48:51]
    v_mfma_f32_16x16x32_bf16 v[64:67], v[172:175], v[192:195], v[64:67]
    v_mfma_f32_16x16x32_bf16 v[20:23], v[160:163], v[196:199], v[20:23]
    v_mfma_f32_16x16x32_bf16 v[36:39], v[164:167], v[196:199], v[36:39]
    v_mfma_f32_16x16x32_bf16 v[52:55], v[168:171], v[196:199], v[52:55]
    v_mfma_f32_16x16x32_bf16 v[68:71], v[172:175], v[196:199], v[68:71]
    v_mfma_f32_16x16x32_bf16 v[24:27], v[160:163], v[200:203], v[24:27]
    v_mfma_f32_16x16x32_bf16 v[40:43], v[164:167], v[200:203], v[40:43]
    v_mfma_f32_16x16x32_bf16 v[56:59], v[168:171], v[200:203], v[56:59]
    ds_read_b32 v210, v208 offset:84
    v_mfma_f32_16x16x32_bf16 v[72:75], v[172:175], v[200:203], v[72:75]
    v_mfma_f32_16x16x32_bf16 v[28:31], v[160:163], v[204:207], v[28:31]
    v_mfma_f32_16x16x32_bf16 v[44:47], v[164:167], v[204:207], v[44:47]
    v_mfma_f32_16x16x32_bf16 v[60:63], v[168:171], v[204:207], v[60:63]
    v_mfma_f32_16x16x32_bf16 v[76:79], v[172:175], v[204:207], v[76:79]
    s_waitcnt lgkmcnt(0)
    v_readfirstlane_b32 s22, v210
    s_cmp_ge_u32 s22, 1
    s_cbranch_scc1 full_30
    v_add_u32 v210, 84, v208
    s_mov_b32 s97, 320000
gb_31:
    ds_read_b32 v211, v210
    s_sub_u32 s97, s97, 1
    s_cbranch_scc1 gbd_32
    s_waitcnt lgkmcnt(0)
    v_readfirstlane_b32 s22, v211
    s_cmp_ge_u32 s22, 1
    s_cbranch_scc1 gbd_32
    s_sleep 1
    s_branch gb_31
gbd_32:
    s_waitcnt lgkmcnt(0)
full_30:
    v_mfma_f32_16x16x32_bf16 v[16:19], v[80:83], v[112:115], v[16:19]
    ds_read_b64_tr_b16 v[144:145], v2 offset:32768
    ds_read_b64_tr_b16 v[146:147], v2 offset:33792
    v_mfma_f32_16x16x32_bf16 v[32:35], v[84:87], v[112:115], v[32:35]
    ds_read_b128 v[176:179], v10 offset:32768
    ds_read_b64_tr_b16 v[148:149], v3 offset:32768
    v_mfma_f32_16x16x32_bf16 v[48:51], v[88:91], v[112:115], v[48:51]
    ds_read_b64_tr_b16 v[150:151], v3 offset:33792
    ds_read_b128 v[180:183], v10 offset:34816
    v_mfma_f32_16x16x32_bf16 v[64:67], v[92:95], v[112:115], v[64:67]
    ds_read_b64_tr_b16 v[152:153], v4 offset:32768
    ds_read_b64_tr_b16 v[154:155], v4 offset:33792
    v_mfma_f32_16x16x32_bf16 v[20:23], v[80:83], v[116:119], v[20:23]
    ds_read_b128 v[184:187], v10 offset:36864
    ds_read_b64_tr_b16 v[156:157], v5 offset:32768
    v_mfma_f32_16x16x32_bf16 v[36:39], v[84:87], v[116:119], v[36:39]
    ds_read_b64_tr_b16 v[158:159], v5 offset:33792
    ds_read_b128 v[188:191], v10 offset:38912
    v_mfma_f32_16x16x32_bf16 v[52:55], v[88:91], v[116:119], v[52:55]
    ds_read_b64_tr_b16 v[160:161], v2 offset:40960
    ds_read_b64_tr_b16 v[162:163], v2 offset:41984
    v_mfma_f32_16x16x32_bf16 v[68:71], v[92:95], v[116:119], v[68:71]
    ds_read_b128 v[192:195], v11 offset:32768
    ds_read_b64_tr_b16 v[164:165], v3 offset:40960
    v_mfma_f32_16x16x32_bf16 v[24:27], v[80:83], v[120:123], v[24:27]
    ds_read_b64_tr_b16 v[166:167], v3 offset:41984
    ds_read_b128 v[196:199], v11 offset:34816
    v_mfma_f32_16x16x32_bf16 v[40:43], v[84:87], v[120:123], v[40:43]
    ds_read_b64_tr_b16 v[168:169], v4 offset:40960
    ds_read_b64_tr_b16 v[170:171], v4 offset:41984
    v_mfma_f32_16x16x32_bf16 v[56:59], v[88:91], v[120:123], v[56:59]
    ds_read_b128 v[200:203], v11 offset:36864
    ds_read_b64_tr_b16 v[172:173], v5 offset:40960
    v_mfma_f32_16x16x32_bf16 v[72:75], v[92:95], v[120:123], v[72:75]
    ds_read_b64_tr_b16 v[174:175], v5 offset:41984
    ds_read_b128 v[204:207], v11 offset:38912
    v_mfma_f32_16x16x32_bf16 v[28:31], v[80:83], v[124:127], v[28:31]
    v_mfma_f32_16x16x32_bf16 v[44:47], v[84:87], v[124:127], v[44:47]
    v_mfma_f32_16x16x32_bf16 v[60:63], v[88:91], v[124:127], v[60:63]
    v_mfma_f32_16x16x32_bf16 v[76:79], v[92:95], v[124:127], v[76:79]
    v_mfma_f32_16x16x32_bf16 v[16:19], v[96:99], v[128:131], v[16:19]
    v_mfma_f32_16x16x32_bf16 v[32:35], v[100:103], v[128:131], v[32:35]
    s_waitcnt lgkmcnt(0)
    s_mov_b64 exec, 1
    ds_add_u32 v208, v209 offset:120
    s_mov_b64 exec, -1
    v_mfma_f32_16x16x32_bf16 v[48:51], v[104:107], v[128:131], v[48:51]
    v_mfma_f32_16x16x32_bf16 v[64:67], v[108:111], v[128:131], v[64:67]
    v_mfma_f32_16x16x32_bf16 v[20:23], v[96:99], v[132:135], v[20:23]
    v_mfma_f32_16x16x32_bf16 v[36:39], v[100:103], v[132:135], v[36:39]
    v_mfma_f32_16x16x32_bf16 v[52:55], v[104:107], v[132:135], v[52:55]
    v_mfma_f32_16x16x32_bf16 v[68:71], v[108:111], v[132:135], v[68:71]
    v_mfma_f32_16x16x32_bf16 v[24:27], v[96:99], v[136:139], v[24:27]
    v_mfma_f32_16x16x32_bf16 v[40:43], v[100:103], v[136:139], v[40:43]
    v_mfma_f32_16x16x32_bf16 v[56:59], v[104:107], v[136:139], v[56:59]
    ds_read_b32 v210, v208 offset:88
    v_mfma_f32_16x16x32_bf16 v[72:75], v[108:111], v[136:139], v[72:75]
    v_mfma_f32_16x16x32_bf16 v[28:31], v[96:99], v[140:143], v[28:31]
    v_mfma_f32_16x16x32_bf16 v[44:47], v[100:103], v[140:143], v[44:47]
    v_mfma_f32_16x16x32_bf16 v[60:63], v[104:107], v[140:143], v[60:63]
    v_mfma_f32_16x16x32_bf16 v[76:79], v[108:111], v[140:143], v[76:79]
    s_waitcnt lgkmcnt(0)
    v_readfirstlane_b32 s22, v210
    s_cmp_ge_u32 s22, 1
    s_cbranch_scc1 full_33
    v_add_u32 v210, 88, v208
    s_mov_b32 s97, 320000
gb_34:
    ds_read_b32 v211, v210
    s_sub_u32 s97, s97, 1
    s_cbranch_scc1 gbd_35
    s_waitcnt lgkmcnt(0)
    v_readfirstlane_b32 s22, v211
    s_cmp_ge_u32 s22, 1
    s_cbranch_scc1 gbd_35
    s_sleep 1
    s_branch gb_34
gbd_35:
    s_waitcnt lgkmcnt(0)
full_33:
    v_mfma_f32_16x16x32_bf16 v[16:19], v[144:147], v[176:179], v[16:19]
    ds_read_b64_tr_b16 v[80:81], v6 offset:0
    ds_read_b64_tr_b16 v[82:83], v6 offset:1024
    v_mfma_f32_16x16x32_bf16 v[32:35], v[148:151], v[176:179], v[32:35]
    ds_read_b128 v[112:115], v12 offset:0
    ds_read_b64_tr_b16 v[84:85], v7 offset:0
    v_mfma_f32_16x16x32_bf16 v[48:51], v[152:155], v[176:179], v[48:51]
    ds_read_b64_tr_b16 v[86:87], v7 offset:1024
    ds_read_b128 v[116:119], v12 offset:2048
    v_mfma_f32_16x16x32_bf16 v[64:67], v[156:159], v[176:179], v[64:67]
    ds_read_b64_tr_b16 v[88:89], v8 offset:0
    ds_read_b64_tr_b16 v[90:91], v8 offset:1024
    v_mfma_f32_16x16x32_bf16 v[20:23], v[144:147], v[180:183], v[20:23]
    ds_read_b128 v[120:123], v12 offset:4096
    ds_read_b64_tr_b16 v[92:93], v9 offset:0
    v_mfma_f32_16x16x32_bf16 v[36:39], v[148:151], v[180:183], v[36:39]
    ds_read_b64_tr_b16 v[94:95], v9 offset:1024
    ds_read_b128 v[124:127], v12 offset:6144
    v_mfma_f32_16x16x32_bf16 v[52:55], v[152:155], v[180:183], v[52:55]
    ds_read_b64_tr_b16 v[96:97], v6 offset:8192
    ds_read_b64_tr_b16 v[98:99], v6 offset:9216
    v_mfma_f32_16x16x32_bf16 v[68:71], v[156:159], v[180:183], v[68:71]
    ds_read_b128 v[128:131], v13 offset:0
    ds_read_b64_tr_b16 v[100:101], v7 offset:8192
    v_mfma_f32_16x16x32_bf16 v[24:27], v[144:147], v[184:187], v[24:27]
    ds_read_b64_tr_b16 v[102:103], v7 offset:9216
    ds_read_b128 v[132:135], v13 offset:2048
    v_mfma_f32_16x16x32_bf16 v[40:43], v[148:151], v[184:187], v[40:43]
    ds_read_b64_tr_b16 v[104:105], v8 offset:8192
    ds_read_b64_tr_b16 v[106:107], v8 offset:9216
    v_mfma_f32_16x16x32_bf16 v[56:59], v[152:155], v[184:187], v[56:59]
    ds_read_b128 v[136:139], v13 offset:4096
    ds_read_b64_tr_b16 v[108:109], v9 offset:8192
    v_mfma_f32_16x16x32_bf16 v[72:75], v[156:159], v[184:187], v[72:75]
    ds_read_b64_tr_b16 v[110:111], v9 offset:9216
    ds_read_b128 v[140:143], v13 offset:6144
    v_mfma_f32_16x16x32_bf16 v[28:31], v[144:147], v[188:191], v[28:31]
    v_mfma_f32_16x16x32_bf16 v[44:47], v[148:151], v[188:191], v[44:47]
    v_mfma_f32_16x16x32_bf16 v[60:63], v[152:155], v[188:191], v[60:63]
    v_mfma_f32_16x16x32_bf16 v[76:79], v[156:159], v[188:191], v[76:79]
    v_mfma_f32_16x16x32_bf16 v[16:19], v[160:163], v[192:195], v[16:19]
    v_mfma_f32_16x16x32_bf16 v[32:35], v[164:167], v[192:195], v[32:35]
    s_waitcnt lgkmcnt(0)
    s_mov_b64 exec, 1
    ds_add_u32 v208, v209 offset:124
    s_mov_b64 exec, -1
    v_mfma_f32_16x16x32_bf16 v[48:51], v[168:171], v[192:195], v[48:51]
    v_mfma_f32_16x16x32_bf16 v[64:67], v[172:175], v[192:195], v[64:67]
    v_mfma_f32_16x16x32_bf16 v[20:23], v[160:163], v[196:199], v[20:23]
    v_mfma_f32_16x16x32_bf16 v[36:39], v[164:167], v[196:199], v[36:39]
    v_mfma_f32_16x16x32_bf16 v[52:55], v[168:171], v[196:199], v[52:55]
    v_mfma_f32_16x16x32_bf16 v[68:71], v[172:175], v[196:199], v[68:71]
    v_mfma_f32_16x16x32_bf16 v[24:27], v[160:163], v[200:203], v[24:27]
    v_mfma_f32_16x16x32_bf16 v[40:43], v[164:167], v[200:203], v[40:43]
    v_mfma_f32_16x16x32_bf16 v[56:59], v[168:171], v[200:203], v[56:59]
    ds_read_b32 v210, v208 offset:92
    v_mfma_f32_16x16x32_bf16 v[72:75], v[172:175], v[200:203], v[72:75]
    v_mfma_f32_16x16x32_bf16 v[28:31], v[160:163], v[204:207], v[28:31]
    v_mfma_f32_16x16x32_bf16 v[44:47], v[164:167], v[204:207], v[44:47]
    v_mfma_f32_16x16x32_bf16 v[60:63], v[168:171], v[204:207], v[60:63]
    v_mfma_f32_16x16x32_bf16 v[76:79], v[172:175], v[204:207], v[76:79]
    s_waitcnt lgkmcnt(0)
    v_readfirstlane_b32 s22, v210
    s_cmp_ge_u32 s22, 1
    s_cbranch_scc1 full_36
    v_add_u32 v210, 92, v208
    s_mov_b32 s97, 320000
gb_37:
    ds_read_b32 v211, v210
    s_sub_u32 s97, s97, 1
    s_cbranch_scc1 gbd_38
    s_waitcnt lgkmcnt(0)
    v_readfirstlane_b32 s22, v211
    s_cmp_ge_u32 s22, 1
    s_cbranch_scc1 gbd_38
    s_sleep 1
    s_branch gb_37
gbd_38:
    s_waitcnt lgkmcnt(0)
full_36:
    v_mfma_f32_16x16x32_bf16 v[16:19], v[80:83], v[112:115], v[16:19]
    ds_read_b64_tr_b16 v[144:145], v6 offset:32768
    ds_read_b64_tr_b16 v[146:147], v6 offset:33792
    v_mfma_f32_16x16x32_bf16 v[32:35], v[84:87], v[112:115], v[32:35]
    ds_read_b128 v[176:179], v12 offset:32768
    ds_read_b64_tr_b16 v[148:149], v7 offset:32768
    v_mfma_f32_16x16x32_bf16 v[48:51], v[88:91], v[112:115], v[48:51]
    ds_read_b64_tr_b16 v[150:151], v7 offset:33792
    ds_read_b128 v[180:183], v12 offset:34816
    v_mfma_f32_16x16x32_bf16 v[64:67], v[92:95], v[112:115], v[64:67]
    ds_read_b64_tr_b16 v[152:153], v8 offset:32768
    ds_read_b64_tr_b16 v[154:155], v8 offset:33792
    v_mfma_f32_16x16x32_bf16 v[20:23], v[80:83], v[116:119], v[20:23]
    ds_read_b128 v[184:187], v12 offset:36864
    ds_read_b64_tr_b16 v[156:157], v9 offset:32768
    v_mfma_f32_16x16x32_bf16 v[36:39], v[84:87], v[116:119], v[36:39]
    ds_read_b64_tr_b16 v[158:159], v9 offset:33792
    ds_read_b128 v[188:191], v12 offset:38912
    v_mfma_f32_16x16x32_bf16 v[52:55], v[88:91], v[116:119], v[52:55]
    ds_read_b64_tr_b16 v[160:161], v6 offset:40960
    ds_read_b64_tr_b16 v[162:163], v6 offset:41984
    v_mfma_f32_16x16x32_bf16 v[68:71], v[92:95], v[116:119], v[68:71]
    ds_read_b128 v[192:195], v13 offset:32768
    ds_read_b64_tr_b16 v[164:165], v7 offset:40960
    v_mfma_f32_16x16x32_bf16 v[24:27], v[80:83], v[120:123], v[24:27]
    ds_read_b64_tr_b16 v[166:167], v7 offset:41984
    ds_read_b128 v[196:199], v13 offset:34816
    v_mfma_f32_16x16x32_bf16 v[40:43], v[84:87], v[120:123], v[40:43]
    ds_read_b64_tr_b16 v[168:169], v8 offset:40960
    ds_read_b64_tr_b16 v[170:171], v8 offset:41984
    v_mfma_f32_16x16x32_bf16 v[56:59], v[88:91], v[120:123], v[56:59]
    ds_read_b128 v[200:203], v13 offset:36864
    ds_read_b64_tr_b16 v[172:173], v9 offset:40960
    v_mfma_f32_16x16x32_bf16 v[72:75], v[92:95], v[120:123], v[72:75]
    ds_read_b64_tr_b16 v[174:175], v9 offset:41984
    ds_read_b128 v[204:207], v13 offset:38912
    v_mfma_f32_16x16x32_bf16 v[28:31], v[80:83], v[124:127], v[28:31]
    v_mfma_f32_16x16x32_bf16 v[44:47], v[84:87], v[124:127], v[44:47]
    v_mfma_f32_16x16x32_bf16 v[60:63], v[88:91], v[124:127], v[60:63]
    v_mfma_f32_16x16x32_bf16 v[76:79], v[92:95], v[124:127], v[76:79]
    v_mfma_f32_16x16x32_bf16 v[16:19], v[96:99], v[128:131], v[16:19]
    v_mfma_f32_16x16x32_bf16 v[32:35], v[100:103], v[128:131], v[32:35]
    s_waitcnt lgkmcnt(0)
    v_mfma_f32_16x16x32_bf16 v[48:51], v[104:107], v[128:131], v[48:51]
    v_mfma_f32_16x16x32_bf16 v[64:67], v[108:111], v[128:131], v[64:67]
    v_mfma_f32_16x16x32_bf16 v[20:23], v[96:99], v[132:135], v[20:23]
    v_mfma_f32_16x16x32_bf16 v[36:39], v[100:103], v[132:135], v[36:39]
    v_mfma_f32_16x16x32_bf16 v[52:55], v[104:107], v[132:135], v[52:55]
    v_mfma_f32_16x16x32_bf16 v[68:71], v[108:111], v[132:135], v[68:71]
    v_mfma_f32_16x16x32_bf16 v[24:27], v[96:99], v[136:139], v[24:27]
    v_mfma_f32_16x16x32_bf16 v[40:43], v[100:103], v[136:139], v[40:43]
    v_mfma_f32_16x16x32_bf16 v[56:59], v[104:107], v[136:139], v[56:59]
    ds_read_b32 v210, v208 offset:96
    v_mfma_f32_16x16x32_bf16 v[72:75], v[108:111], v[136:139], v[72:75]
    v_mfma_f32_16x16x32_bf16 v[28:31], v[96:99], v[140:143], v[28:31]
    v_mfma_f32_16x16x32_bf16 v[44:47], v[100:103], v[140:143], v[44:47]
    v_mfma_f32_16x16x32_bf16 v[60:63], v[104:107], v[140:143], v[60:63]
    v_mfma_f32_16x16x32_bf16 v[76:79], v[108:111], v[140:143], v[76:79]
    s_waitcnt lgkmcnt(0)
    v_readfirstlane_b32 s22, v210
    s_cmp_ge_u32 s22, 1
    s_cbranch_scc1 full_39
    v_add_u32 v210, 96, v208
    s_mov_b32 s97, 320000
gb_40:
    ds_read_b32 v211, v210
    s_sub_u32 s97, s97, 1
    s_cbranch_scc1 gbd_41
    s_waitcnt lgkmcnt(0)
    v_readfirstlane_b32 s22, v211
    s_cmp_ge_u32 s22, 1
    s_cbranch_scc1 gbd_41
    s_sleep 1
    s_branch gb_40
gbd_41:
    s_waitcnt lgkmcnt(0)
full_39:
    v_mfma_f32_16x16x32_bf16 v[16:19], v[144:147], v[176:179], v[16:19]
    ds_read_b64_tr_b16 v[80:81], v2 offset:0
    ds_read_b64_tr_b16 v[82:83], v2 offset:1024
    v_mfma_f32_16x16x32_bf16 v[32:35], v[148:151], v[176:179], v[32:35]
    ds_read_b128 v[112:115], v10 offset:0
    ds_read_b64_tr_b16 v[84:85], v3 offset:0
    v_mfma_f32_16x16x32_bf16 v[48:51], v[152:155], v[176:179], v[48:51]
    ds_read_b64_tr_b16 v[86:87], v3 offset:1024
    ds_read_b128 v[116:119], v10 offset:2048
    v_mfma_f32_16x16x32_bf16 v[64:67], v[156:159], v[176:179], v[64:67]
    ds_read_b64_tr_b16 v[88:89], v4 offset:0
    ds_read_b64_tr_b16 v[90:91], v4 offset:1024
    v_mfma_f32_16x16x32_bf16 v[20:23], v[144:147], v[180:183], v[20:23]
    ds_read_b128 v[120:123], v10 offset:4096
    ds_read_b64_tr_b16 v[92:93], v5 offset:0
    v_mfma_f32_16x16x32_bf16 v[36:39], v[148:151], v[180:183], v[36:39]
    ds_read_b64_tr_b16 v[94:95], v5 offset:1024
    ds_read_b128 v[124:127], v10 offset:6144
    v_mfma_f32_16x16x32_bf16 v[52:55], v[152:155], v[180:183], v[52:55]
    ds_read_b64_tr_b16 v[96:97], v2 offset:8192
    ds_read_b64_tr_b16 v[98:99], v2 offset:9216
    v_mfma_f32_16x16x32_bf16 v[68:71], v[156:159], v[180:183], v[68:71]
    ds_read_b128 v[128:131], v11 offset:0
    ds_read_b64_tr_b16 v[100:101], v3 offset:8192
    v_mfma_f32_16x16x32_bf16 v[24:27], v[144:147], v[184:187], v[24:27]
    ds_read_b64_tr_b16 v[102:103], v3 offset:9216
    ds_read_b128 v[132:135], v11 offset:2048
    v_mfma_f32_16x16x32_bf16 v[40:43], v[148:151], v[184:187], v[40:43]
    ds_read_b64_tr_b16 v[104:105], v4 offset:8192
    ds_read_b64_tr_b16 v[106:107], v4 offset:9216
    v_mfma_f32_16x16x32_bf16 v[56:59], v[152:155], v[184:187], v[56:59]
    ds_read_b128 v[136:139], v11 offset:4096
    ds_read_b64_tr_b16 v[108:109], v5 offset:8192
    v_mfma_f32_16x16x32_bf16 v[72:75], v[156:159], v[184:187], v[72:75]
    ds_read_b64_tr_b16 v[110:111], v5 offset:9216
    ds_read_b128 v[140:143], v11 offset:6144
    v_mfma_f32_16x16x32_bf16 v[28:31], v[144:147], v[188:191], v[28:31]
    v_mfma_f32_16x16x32_bf16 v[44:47], v[148:151], v[188:191], v[44:47]
    v_mfma_f32_16x16x32_bf16 v[60:63], v[152:155], v[188:191], v[60:63]
    v_mfma_f32_16x16x32_bf16 v[76:79], v[156:159], v[188:191], v[76:79]
    v_mfma_f32_16x16x32_bf16 v[16:19], v[160:163], v[192:195], v[16:19]
    v_mfma_f32_16x16x32_bf16 v[32:35], v[164:167], v[192:195], v[32:35]
    s_waitcnt lgkmcnt(0)
    v_mfma_f32_16x16x32_bf16 v[48:51], v[168:171], v[192:195], v[48:51]
    v_mfma_f32_16x16x32_bf16 v[64:67], v[172:175], v[192:195], v[64:67]
    v_mfma_f32_16x16x32_bf16 v[20:23], v[160:163], v[196:199], v[20:23]
    v_mfma_f32_16x16x32_bf16 v[36:39], v[164:167], v[196:199], v[36:39]
    v_mfma_f32_16x16x32_bf16 v[52:55], v[168:171], v[196:199], v[52:55]
    v_mfma_f32_16x16x32_bf16 v[68:71], v[172:175], v[196:199], v[68:71]
    v_mfma_f32_16x16x32_bf16 v[24:27], v[160:163], v[200:203], v[24:27]
    v_mfma_f32_16x16x32_bf16 v[40:43], v[164:167], v[200:203], v[40:43]
    v_mfma_f32_16x16x32_bf16 v[56:59], v[168:171], v[200:203], v[56:59]
    v_mfma_f32_16x16x32_bf16 v[72:75], v[172:175], v[200:203], v[72:75]
    v_mfma_f32_16x16x32_bf16 v[28:31], v[160:163], v[204:207], v[28:31]
    v_mfma_f32_16x16x32_bf16 v[44:47], v[164:167], v[204:207], v[44:47]
    v_mfma_f32_16x16x32_bf16 v[60:63], v[168:171], v[204:207], v[60:63]
    v_mfma_f32_16x16x32_bf16 v[76:79], v[172:175], v[204:207], v[76:79]
    s_waitcnt lgkmcnt(0)
    v_mfma_f32_16x16x32_bf16 v[16:19], v[80:83], v[112:115], v[16:19]
    v_mfma_f32_16x16x32_bf16 v[32:35], v[84:87], v[112:115], v[32:35]
    v_mfma_f32_16x16x32_bf16 v[48:51], v[88:91], v[112:115], v[48:51]
    v_mfma_f32_16x16x32_bf16 v[64:67], v[92:95], v[112:115], v[64:67]
    v_mfma_f32_16x16x32_bf16 v[20:23], v[80:83], v[116:119], v[20:23]
    v_mfma_f32_16x16x32_bf16 v[36:39], v[84:87], v[116:119], v[36:39]
    v_mfma_f32_16x16x32_bf16 v[52:55], v[88:91], v[116:119], v[52:55]
    v_mfma_f32_16x16x32_bf16 v[68:71], v[92:95], v[116:119], v[68:71]
    v_mfma_f32_16x16x32_bf16 v[24:27], v[80:83], v[120:123], v[24:27]
    v_mfma_f32_16x16x32_bf16 v[40:43], v[84:87], v[120:123], v[40:43]
    v_mfma_f32_16x16x32_bf16 v[56:59], v[88:91], v[120:123], v[56:59]
    v_mfma_f32_16x16x32_bf16 v[72:75], v[92:95], v[120:123], v[72:75]
    v_mfma_f32_16x16x32_bf16 v[28:31], v[80:83], v[124:127], v[28:31]
    v_mfma_f32_16x16x32_bf16 v[44:47], v[84:87], v[124:127], v[44:47]
    v_mfma_f32_16x16x32_bf16 v[60:63], v[88:91], v[124:127], v[60:63]
    v_mfma_f32_16x16x32_bf16 v[76:79], v[92:95], v[124:127], v[76:79]
    v_mfma_f32_16x16x32_bf16 v[16:19], v[96:99], v[128:131], v[16:19]
    v_mfma_f32_16x16x32_bf16 v[32:35], v[100:103], v[128:131], v[32:35]
    v_mfma_f32_16x16x32_bf16 v[48:51], v[104:107], v[128:131], v[48:51]
    v_mfma_f32_16x16x32_bf16 v[64:67], v[108:111], v[128:131], v[64:67]
    v_mfma_f32_16x16x32_bf16 v[20:23], v[96:99], v[132:135], v[20:23]
    v_mfma_f32_16x16x32_bf16 v[36:39], v[100:103], v[132:135], v[36:39]
    v_mfma_f32_16x16x32_bf16 v[52:55], v[104:107], v[132:135], v[52:55]
    v_mfma_f32_16x16x32_bf16 v[68:71], v[108:111], v[132:135], v[68:71]
    v_mfma_f32_16x16x32_bf16 v[24:27], v[96:99], v[136:139], v[24:27]
    v_mfma_f32_16x16x32_bf16 v[40:43], v[100:103], v[136:139], v[40:43]
    v_mfma_f32_16x16x32_bf16 v[56:59], v[104:107], v[136:139], v[56:59]
    v_mfma_f32_16x16x32_bf16 v[72:75], v[108:111], v[136:139], v[72:75]
    v_mfma_f32_16x16x32_bf16 v[28:31], v[96:99], v[140:143], v[28:31]
    v_mfma_f32_16x16x32_bf16 v[44:47], v[100:103], v[140:143], v[44:47]
    v_mfma_f32_16x16x32_bf16 v[60:63], v[104:107], v[140:143], v[60:63]
    v_mfma_f32_16x16x32_bf16 v[76:79], v[108:111], v[140:143], v[76:79]
    s_cmp_lt_u32 s56, 432
    s_cbranch_scc1 L_qkv
    s_nop 7
    v_cvt_pk_bf16_f32 v208, 0, v16
    v_cvt_pk_bf16_f32 v209, 0, v20
    v_cvt_pk_bf16_f32 v210, 0, v24
    v_cvt_pk_bf16_f32 v211, 0, v28
    v_mul_f32 v208, 0xbfb8aa3b, v208
    v_mul_f32 v209, 0xbfb8aa3b, v209
    v_mul_f32 v210, 0xbfb8aa3b, v210
    v_mul_f32 v211, 0xbfb8aa3b, v211
    v_exp_f32 v208, v208
    v_exp_f32 v209, v209
    v_exp_f32 v210, v210
    v_exp_f32 v211, v211
    v_add_f32 v208, 1.0, v208
    v_add_f32 v209, 1.0, v209
    v_add_f32 v210, 1.0, v210
    v_add_f32 v211, 1.0, v211
    v_rcp_f32 v208, v208
    v_rcp_f32 v209, v209
    v_rcp_f32 v210, v210
    v_rcp_f32 v211, v211
    v_cvt_pk_bf16_f32 v208, 0, v208
    v_cvt_pk_bf16_f32 v209, 0, v209
    v_cvt_pk_bf16_f32 v210, 0, v210
    v_cvt_pk_bf16_f32 v211, 0, v211
    v_and_b32 v2, 0x3fff, v1
    v_lshrrev_b32 v2, 1, v2
    s_mov_b32 s19, 14155776
    s_mov_b32 exec_lo, 0xffff
    s_mov_b32 exec_hi, 0x0
    buffer_store_dwordx2 v[208:209], v2, s[36:39], s19 offen sc1
    buffer_store_dwordx2 v[210:211], v2, s[36:39], s19 offen offset:128 sc1
    s_mov_b64 exec, -1
    s_branch L_mdone
L_qkv:
    s_mov_b32 s20, 0x3eae1a93
    s_cmp_lt_u32 s56, 144
    s_cselect_b32 s21, s20, 1.0
    s_nop 3
    v_mul_f32 v16, s21, v16
    v_mul_f32 v17, s21, v17
    v_mul_f32 v18, s21, v18
    v_mul_f32 v19, s21, v19
    v_cvt_pk_bf16_f32 v144, v16, v17
    v_cvt_pk_bf16_f32 v145, v18, v19
    v_mul_f32 v20, s21, v20
    v_mul_f32 v21, s21, v21
    v_mul_f32 v22, s21, v22
    v_mul_f32 v23, s21, v23
    v_cvt_pk_bf16_f32 v146, v20, v21
    v_cvt_pk_bf16_f32 v147, v22, v23
    v_mul_f32 v24, s21, v24
    v_mul_f32 v25, s21, v25
    v_mul_f32 v26, s21, v26
    v_mul_f32 v27, s21, v27
    v_cvt_pk_bf16_f32 v148, v24, v25
    v_cvt_pk_bf16_f32 v149, v26, v27
    v_mul_f32 v28, s21, v28
    v_mul_f32 v29, s21, v29
    v_mul_f32 v30, s21, v30
    v_mul_f32 v31, s21, v31
    v_cvt_pk_bf16_f32 v150, v28, v29
    v_cvt_pk_bf16_f32 v151, v30, v31
    s_mov_b32 s19, 0
    buffer_store_dwordx4 v[144:147], v1, s[48:51], s19 offen sc1
    buffer_store_dwordx4 v[148:151], v1, s[48:51], s19 offen offset:256 sc1
    v_mul_f32 v32, s21, v32
    v_mul_f32 v33, s21, v33
    v_mul_f32 v34, s21, v34
    v_mul_f32 v35, s21, v35
    v_cvt_pk_bf16_f32 v152, v32, v33
    v_cvt_pk_bf16_f32 v153, v34, v35
    v_mul_f32 v36, s21, v36
    v_mul_f32 v37, s21, v37
    v_mul_f32 v38, s21, v38
    v_mul_f32 v39, s21, v39
    v_cvt_pk_bf16_f32 v154, v36, v37
    v_cvt_pk_bf16_f32 v155, v38, v39
    v_mul_f32 v40, s21, v40
    v_mul_f32 v41, s21, v41
    v_mul_f32 v42, s21, v42
    v_mul_f32 v43, s21, v43
    v_cvt_pk_bf16_f32 v156, v40, v41
    v_cvt_pk_bf16_f32 v157, v42, v43
    v_mul_f32 v44, s21, v44
    v_mul_f32 v45, s21, v45
    v_mul_f32 v46, s21, v46
    v_mul_f32 v47, s21, v47
    v_cvt_pk_bf16_f32 v158, v44, v45
    v_cvt_pk_bf16_f32 v159, v46, v47
    s_mov_b32 s19, 65536
    buffer_store_dwordx4 v[152:155], v1, s[48:51], s19 offen sc1
    buffer_store_dwordx4 v[156:159], v1, s[48:51], s19 offen offset:256 sc1
    v_mul_f32 v48, s21, v48
    v_mul_f32 v49, s21, v49
    v_mul_f32 v50, s21, v50
    v_mul_f32 v51, s21, v51
    v_cvt_pk_bf16_f32 v160, v48, v49
    v_cvt_pk_bf16_f32 v161, v50, v51
    v_mul_f32 v52, s21, v52
    v_mul_f32 v53, s21, v53
    v_mul_f32 v54, s21, v54
    v_mul_f32 v55, s21, v55
    v_cvt_pk_bf16_f32 v162, v52, v53
    v_cvt_pk_bf16_f32 v163, v54, v55
    v_mul_f32 v56, s21, v56
    v_mul_f32 v57, s21, v57
    v_mul_f32 v58, s21, v58
    v_mul_f32 v59, s21, v59
    v_cvt_pk_bf16_f32 v164, v56, v57
    v_cvt_pk_bf16_f32 v165, v58, v59
    v_mul_f32 v60, s21, v60
    v_mul_f32 v61, s21, v61
    v_mul_f32 v62, s21, v62
    v_mul_f32 v63, s21, v63
    v_cvt_pk_bf16_f32 v166, v60, v61
    v_cvt_pk_bf16_f32 v167, v62, v63
    s_mov_b32 s19, 131072
    buffer_store_dwordx4 v[160:163], v1, s[48:51], s19 offen sc1
    buffer_store_dwordx4 v[164:167], v1, s[48:51], s19 offen offset:256 sc1
    v_mul_f32 v64, s21, v64
    v_mul_f32 v65, s21, v65
    v_mul_f32 v66, s21, v66
    v_mul_f32 v67, s21, v67
    v_cvt_pk_bf16_f32 v168, v64, v65
    v_cvt_pk_bf16_f32 v169, v66, v67
    v_mul_f32 v68, s21, v68
    v_mul_f32 v69, s21, v69
    v_mul_f32 v70, s21, v70
    v_mul_f32 v71, s21, v71
    v_cvt_pk_bf16_f32 v170, v68, v69
    v_cvt_pk_bf16_f32 v171, v70, v71
    v_mul_f32 v72, s21, v72
    v_mul_f32 v73, s21, v73
    v_mul_f32 v74, s21, v74
    v_mul_f32 v75, s21, v75
    v_cvt_pk_bf16_f32 v172, v72, v73
    v_cvt_pk_bf16_f32 v173, v74, v75
    v_mul_f32 v76, s21, v76
    v_mul_f32 v77, s21, v77
    v_mul_f32 v78, s21, v78
    v_mul_f32 v79, s21, v79
    v_cvt_pk_bf16_f32 v174, v76, v77
    v_cvt_pk_bf16_f32 v175, v78, v79
    s_mov_b32 s19, 196608
    buffer_store_dwordx4 v[168:171], v1, s[48:51], s19 offen sc1
    buffer_store_dwordx4 v[172:175], v1, s[48:51], s19 offen offset:256 sc1
L_mdone:
    s_setprio 0
    s_waitcnt vmcnt(0)
    v_mov_b32 v1, 22024
    v_mov_b32 v2, 1
    s_mov_b64 exec, 1
    ds_add_rtn_u32 v2, v1, v2
    s_mov_b64 exec, -1
    s_waitcnt lgkmcnt(0)
    v_readfirstlane_b32 s22, v2
    s_cmp_lg_u32 s22, 3
    s_cbranch_scc1 L_cvwait
    s_lshl_b32 s22, s2, 7
    s_add_u32 s22, s22, 14163976
    v_mov_b32 v120, s22
    v_mov_b32 v122, s88
    v_mov_b32 v123, s89
    s_mov_b64 exec, 1
    buffer_store_dwordx2 v[122:123], v120, s[36:39], 0 offen sc0 sc1
    s_mov_b64 exec, -1
    s_branch L_cvwait
L_spare:
    s_and_b32 s46, s2, 31
    s_and_b32 s58, s18, 3
    s_lshr_b32 s59, s18, 2
    s_lshl_b32 s3, s46, 2
    s_add_u32 s3, s3, s59
    s_mov_b32 s94, 2
    s_add_u32 s90, s90, 2
    s_waitcnt lgkmcnt(0)
    s_mov_b32 s36, s16
    s_mov_b32 s37, s17
    s_mov_b32 s38, 14196864
    s_mov_b32 s39, 0x00020000
    s_mov_b32 s48, s14
    s_mov_b32 s49, s15
    s_mov_b32 s50, 2359296
    s_mov_b32 s51, 0x00020000
    s_lshl_b32 s19, s46, 2
    s_add_u32 s19, s19, s95
    s_lshl_b32 s19, s19, 12
    v_lshlrev_b32 v2, 4, v0
    buffer_load_dwordx4 v[164:167], v2, s[48:51], s19 offen offset:0
    buffer_load_dwordx4 v[168:171], v2, s[48:51], s19 offen offset:1024
    buffer_load_dwordx4 v[172:175], v2, s[48:51], s19 offen offset:2048
    buffer_load_dwordx4 v[176:179], v2, s[48:51], s19 offen offset:3072
    s_waitcnt vmcnt(4)
    v_readfirstlane_b32 s88, v214
    v_readfirstlane_b32 s89, v215
    v_mov_b32 v212, 22208
    s_add_u32 s88, s88, 1
    s_addc_u32 s89, s89, 0
    s_or_b32 s89, s89, 0x80000000
    v_mov_b32 v214, s88
    v_mov_b32 v215, s89
    ds_write_b64 v212, v[214:215]
    v_lshlrev_b32 v200, 7, v208
    v_lshl_add_u32 v200, v209, 4, v200
    v_add_u32 v200, s98, v200
    v_lshl_add_u32 v201, v209, 6, s98
    ds_read_b128 v[116:119], v200 offset:64
    ds_read_b128 v[120:123], v200 offset:128
    ds_read_b128 v[124:127], v200 offset:192
    ds_read_b128 v[128:131], v200 offset:256
    ds_read_b128 v[132:135], v200 offset:320
    ds_read_b128 v[136:139], v201 offset:2304
    ds_read_b128 v[140:143], v201 offset:2320
    ds_read_b128 v[144:147], v201 offset:2336
    ds_read_b128 v[148:151], v201 offset:2352
    s_mov_b32 s42, 0xffff0000
    v_lshrrev_b32 v202, 3, v0
    v_mul_u32_u24 v202, 288, v202
    v_and_b32 v203, 1, v208
    v_lshl_add_u32 v202, v203, 2, v202
    v_add_u32 v202, v202, v201
    v_add_u32 v202, 2560, v202
    v_bfe_u32 v203, v0, 2, 2
    v_sub_u32 v203, 3, v203
    v_mul_u32_u24 v203, 288, v203
    v_lshrrev_b32 v204, 4, v0
    v_lshl_add_u32 v203, v204, 5, v203
    v_lshl_add_u32 v203, v209, 3, v203
    v_add_u32 v203, s98, v203
    v_lshlrev_b32 v204, 12, v208
    v_lshl_add_u32 v204, v209, 4, v204
    s_lshl_b32 s22, s41, 17
    s_lshl_b32 s23, s40, 6
    s_add_u32 s22, s22, s23
    s_add_u32 s22, s22, 7077888
    s_add_u32 s23, s22, 65536
    v_lshlrev_b32 v100, 16, v180
    v_and_b32 v101, s42, v180
    v_lshlrev_b32 v102, 16, v181
    v_and_b32 v103, s42, v181
    v_lshlrev_b32 v104, 16, v184
    v_and_b32 v105, s42, v184
    v_lshlrev_b32 v106, 16, v185
    v_and_b32 v107, s42, v185
    s_waitcnt lgkmcnt(4)
    v_lshlrev_b32 v64, 16, v116
    v_and_b32 v65, s42, v116
    v_lshlrev_b32 v66, 16, v117
    v_and_b32 v67, s42, v117
    v_lshlrev_b32 v68, 16, v120
    v_and_b32 v69, s42, v120
    v_lshlrev_b32 v70, 16, v121
    v_and_b32 v71, s42, v121
    v_lshlrev_b32 v72, 16, v124
    v_and_b32 v73, s42, v124
    v_lshlrev_b32 v74, 16, v125
    v_and_b32 v75, s42, v125
    v_lshlrev_b32 v76, 16, v128
    v_and_b32 v77, s42, v128
    v_lshlrev_b32 v78, 16, v129
    v_and_b32 v79, s42, v129
    v_lshlrev_b32 v80, 16, v132
    v_and_b32 v81, s42, v132
    v_lshlrev_b32 v82, 16, v133
    v_and_b32 v83, s42, v133
    s_waitcnt lgkmcnt(0)
    v_lshlrev_b32 v84, 16, v136
    v_and_b32 v85, s42, v136
    v_lshlrev_b32 v86, 16, v137
    v_and_b32 v87, s42, v137
    v_lshlrev_b32 v88, 16, v138
    v_and_b32 v89, s42, v138
    v_lshlrev_b32 v90, 16, v139
    v_and_b32 v91, s42, v139
    v_lshlrev_b32 v92, 16, v140
    v_and_b32 v93, s42, v140
    v_lshlrev_b32 v94, 16, v141
    v_and_b32 v95, s42, v141
    v_lshlrev_b32 v96, 16, v142
    v_and_b32 v97, s42, v142
    v_lshlrev_b32 v98, 16, v143
    v_and_b32 v99, s42, v143
    v_mul_f32 v108, v64, v87
    v_mul_f32 v109, v65, v91
    v_mul_f32 v110, v66, v95
    v_mul_f32 v111, v67, v99
    v_mul_f32 v112, v68, v87
    v_mul_f32 v113, v69, v91
    v_mul_f32 v114, v70, v95
    v_mul_f32 v115, v71, v99
    v_fmac_f32 v108, v68, v86
    v_fmac_f32 v109, v69, v90
    v_fmac_f32 v110, v70, v94
    v_fmac_f32 v111, v71, v98
    v_fmac_f32 v112, v72, v86
    v_fmac_f32 v113, v73, v90
    v_fmac_f32 v114, v74, v94
    v_fmac_f32 v115, v75, v98
    v_fmac_f32 v108, v72, v85
    v_fmac_f32 v109, v73, v89
    v_fmac_f32 v110, v74, v93
    v_fmac_f32 v111, v75, v97
    v_fmac_f32 v112, v76, v85
    v_fmac_f32 v113, v77, v89
    v_fmac_f32 v114, v78, v93
    v_fmac_f32 v115, v79, v97
    v_fmac_f32 v108, v76, v84
    v_fmac_f32 v109, v77, v88
    v_fmac_f32 v110, v78, v92
    v_fmac_f32 v111, v79, v96
    v_fmac_f32 v112, v80, v84
    v_fmac_f32 v113, v81, v88
    v_fmac_f32 v114, v82, v92
    v_fmac_f32 v115, v83, v96
    v_cvt_pk_bf16_f32 v108, 0, v108
    v_cvt_pk_bf16_f32 v109, 0, v109
    v_cvt_pk_bf16_f32 v110, 0, v110
    v_cvt_pk_bf16_f32 v111, 0, v111
    v_cvt_pk_bf16_f32 v112, 0, v112
    v_cvt_pk_bf16_f32 v113, 0, v113
    v_cvt_pk_bf16_f32 v114, 0, v114
    v_cvt_pk_bf16_f32 v115, 0, v115
    v_mul_f32 v108, v108, v100
    v_mul_f32 v109, v109, v101
    v_mul_f32 v110, v110, v102
    v_mul_f32 v111, v111, v103
    v_mul_f32 v112, v112, v104
    v_mul_f32 v113, v113, v105
    v_mul_f32 v114, v114, v106
    v_mul_f32 v115, v115, v107
    v_cvt_pk_bf16_f32 v152, v108, v112
    v_cvt_pk_bf16_f32 v153, v109, v113
    v_cvt_pk_bf16_f32 v154, v110, v114
    v_cvt_pk_bf16_f32 v155, v111, v115
    ds_write2_b32 v202, v152, v153 offset0:0 offset1:2
    ds_write2_b32 v202, v154, v155 offset0:4 offset1:6
    v_lshlrev_b32 v100, 16, v182
    v_and_b32 v101, s42, v182
    v_lshlrev_b32 v102, 16, v183
    v_and_b32 v103, s42, v183
    v_lshlrev_b32 v104, 16, v186
    v_and_b32 v105, s42, v186
    v_lshlrev_b32 v106, 16, v187
    v_and_b32 v107, s42, v187
    v_lshlrev_b32 v64, 16, v118
    v_and_b32 v65, s42, v118
    v_lshlrev_b32 v66, 16, v119
    v_and_b32 v67, s42, v119
    v_lshlrev_b32 v68, 16, v122
    v_and_b32 v69, s42, v122
    v_lshlrev_b32 v70, 16, v123
    v_and_b32 v71, s42, v123
    v_lshlrev_b32 v72, 16, v126
    v_and_b32 v73, s42, v126
    v_lshlrev_b32 v74, 16, v127
    v_and_b32 v75, s42, v127
    v_lshlrev_b32 v76, 16, v130
    v_and_b32 v77, s42, v130
    v_lshlrev_b32 v78, 16, v131
    v_and_b32 v79, s42, v131
    v_lshlrev_b32 v80, 16, v134
    v_and_b32 v81, s42, v134
    v_lshlrev_b32 v82, 16, v135
    v_and_b32 v83, s42, v135
    v_lshlrev_b32 v84, 16, v144
    v_and_b32 v85, s42, v144
    v_lshlrev_b32 v86, 16, v145
    v_and_b32 v87, s42, v145
    v_lshlrev_b32 v88, 16, v146
    v_and_b32 v89, s42, v146
    v_lshlrev_b32 v90, 16, v147
    v_and_b32 v91, s42, v147
    v_lshlrev_b32 v92, 16, v148
    v_and_b32 v93, s42, v148
    v_lshlrev_b32 v94, 16, v149
    v_and_b32 v95, s42, v149
    v_lshlrev_b32 v96, 16, v150
    v_and_b32 v97, s42, v150
    v_lshlrev_b32 v98, 16, v151
    v_and_b32 v99, s42, v151
    v_mul_f32 v108, v64, v87
    v_mul_f32 v109, v65, v91
    v_mul_f32 v110, v66, v95
    v_mul_f32 v111, v67, v99
    v_mul_f32 v112, v68, v87
    v_mul_f32 v113, v69, v91
    v_mul_f32 v114, v70, v95
    v_mul_f32 v115, v71, v99
    v_fmac_f32 v108, v68, v86
    v_fmac_f32 v109, v69, v90
    v_fmac_f32 v110, v70, v94
    v_fmac_f32 v111, v71, v98
    v_fmac_f32 v112, v72, v86
    v_fmac_f32 v113, v73, v90
    v_fmac_f32 v114, v74, v94
    v_fmac_f32 v115, v75, v98
    v_fmac_f32 v108, v72, v85
    v_fmac_f32 v109, v73, v89
    v_fmac_f32 v110, v74, v93
    v_fmac_f32 v111, v75, v97
    v_fmac_f32 v112, v76, v85
    v_fmac_f32 v113, v77, v89
    v_fmac_f32 v114, v78, v93
    v_fmac_f32 v115, v79, v97
    v_fmac_f32 v108, v76, v84
    v_fmac_f32 v109, v77, v88
    v_fmac_f32 v110, v78, v92
    v_fmac_f32 v111, v79, v96
    v_fmac_f32 v112, v80, v84
    v_fmac_f32 v113, v81, v88
    v_fmac_f32 v114, v82, v92
    v_fmac_f32 v115, v83, v96
    v_cvt_pk_bf16_f32 v108, 0, v108
    v_cvt_pk_bf16_f32 v109, 0, v109
    v_cvt_pk_bf16_f32 v110, 0, v110
    v_cvt_pk_bf16_f32 v111, 0, v111
    v_cvt_pk_bf16_f32 v112, 0, v112
    v_cvt_pk_bf16_f32 v113, 0, v113
    v_cvt_pk_bf16_f32 v114, 0, v114
    v_cvt_pk_bf16_f32 v115, 0, v115
    v_mul_f32 v108, v108, v100
    v_mul_f32 v109, v109, v101
    v_mul_f32 v110, v110, v102
    v_mul_f32 v111, v111, v103
    v_mul_f32 v112, v112, v104
    v_mul_f32 v113, v113, v105
    v_mul_f32 v114, v114, v106
    v_mul_f32 v115, v115, v107
    v_cvt_pk_bf16_f32 v156, v108, v112
    v_cvt_pk_bf16_f32 v157, v109, v113
    v_cvt_pk_bf16_f32 v158, v110, v114
    v_cvt_pk_bf16_f32 v159, v111, v115
    ds_write2_b32 v202, v156, v157 offset0:8 offset1:10
    ds_write2_b32 v202, v158, v159 offset0:12 offset1:14
    ds_read_b64_tr_b16 v[64:65], v203 offset:3712
    ds_read_b64_tr_b16 v[66:67], v203 offset:2560
    ds_read_b64_tr_b16 v[68:69], v203 offset:3840
    ds_read_b64_tr_b16 v[70:71], v203 offset:2688
    s_waitcnt lgkmcnt(2)
    buffer_store_dwordx4 v[64:67], v204, s[36:39], s22 offen sc1
    s_waitcnt lgkmcnt(0)
    buffer_store_dwordx4 v[68:71], v204, s[36:39], s23 offen sc1
    v_lshlrev_b32 v2, 7, v0
    s_lshl_b32 s19, s46, 3
    s_add_u32 s19, s19, s18
    s_mul_i32 s19, s19, 7168
    s_add_u32 s19, s19, 524288
    s_mov_b32 exec_lo, 0xffffffff
    s_mov_b32 exec_hi, 0xffffff
    buffer_load_dword v210, v2, s[48:51], s19 offen
    s_mov_b64 exec, -1
    s_waitcnt vmcnt(1) lgkmcnt(0)
    s_barrier
    s_cmp_lg_u32 s18, 4
    s_cbranch_scc1 L_spc
    s_lshl_b32 s22, s2, 7
    s_add_u32 s22, s22, 14163968
    v_mov_b32 v8, s22
    v_mov_b32 v10, s88
    v_mov_b32 v11, s89
    s_mov_b64 exec, 1
    buffer_store_dwordx2 v[10:11], v8, s[36:39], 0 offen sc0 sc1
    s_mov_b64 exec, -1
L_spc:
    s_mov_b32 s100, s91
    s_mov_b32 s101, s92
    s_lshl_b32 s19, s59, 16
    s_add_u32 s91, s91, s19
    s_sub_u32 s91, s91, 32768
    s_add_u32 s92, s92, 9728
    s_add_u32 s56, s3, 2
    s_cmp_ge_u32 s18, 4
    s_cbranch_scc1 L_spk
    s_mul_i32 s41, s18, 3
    s_sub_u32 s19, s18, 1
    s_cmp_ge_u32 s18, 2
    s_cselect_b32 s41, s19, s41
    s_lshl_b32 s41, s41, 15
    s_add_u32 s41, s41, 24576
    v_mov_b32 v6, 0
    v_mov_b32 v7, 0
    s_nop 1
    v_mov_b32_dpp v6, v166 wave_shr:1 row_mask:0xf bank_mask:0xf
    v_mov_b32_dpp v7, v167 wave_shr:1 row_mask:0xf bank_mask:0xf
    v_alignbit_b32 v64, v164, v7, 16
    v_alignbit_b32 v65, v165, v164, 16
    v_alignbit_b32 v66, v166, v165, 16
    v_alignbit_b32 v67, v167, v166, 16
    v_mov_b32 v68, v7
    v_mov_b32 v69, v164
    v_mov_b32 v70, v165
    v_mov_b32 v71, v166
    v_alignbit_b32 v72, v7, v6, 16
    v_mov_b32 v73, v64
    v_mov_b32 v74, v65
    v_mov_b32 v75, v66
    v_mov_b32 v6, 0
    v_mov_b32 v7, 0
    v_readlane_b32 s20, v166, 63
    v_readlane_b32 s21, v167, 63
    s_nop 1
    v_mov_b32 v6, s20
    v_mov_b32 v7, s21
    s_nop 1
    v_mov_b32_dpp v6, v170 wave_shr:1 row_mask:0xf bank_mask:0xf
    v_mov_b32_dpp v7, v171 wave_shr:1 row_mask:0xf bank_mask:0xf
    v_alignbit_b32 v76, v168, v7, 16
    v_alignbit_b32 v77, v169, v168, 16
    v_alignbit_b32 v78, v170, v169, 16
    v_alignbit_b32 v79, v171, v170, 16
    v_mov_b32 v80, v7
    v_mov_b32 v81, v168
    v_mov_b32 v82, v169
    v_mov_b32 v83, v170
    v_alignbit_b32 v84, v7, v6, 16
    v_mov_b32 v85, v76
    v_mov_b32 v86, v77
    v_mov_b32 v87, v78
    v_mov_b32 v6, 0
    v_mov_b32 v7, 0
    v_readlane_b32 s20, v170, 63
    v_readlane_b32 s21, v171, 63
    s_nop 1
    v_mov_b32 v6, s20
    v_mov_b32 v7, s21
    s_nop 1
    v_mov_b32_dpp v6, v174 wave_shr:1 row_mask:0xf bank_mask:0xf
    v_mov_b32_dpp v7, v175 wave_shr:1 row_mask:0xf bank_mask:0xf
    v_alignbit_b32 v88, v172, v7, 16
    v_alignbit_b32 v89, v173, v172, 16
    v_alignbit_b32 v90, v174, v173, 16
    v_alignbit_b32 v91, v175, v174, 16
    v_mov_b32 v92, v7
    v_mov_b32 v93, v172
    v_mov_b32 v94, v173
    v_mov_b32 v95, v174
    v_alignbit_b32 v96, v7, v6, 16
    v_mov_b32 v97, v88
    v_mov_b32 v98, v89
    v_mov_b32 v99, v90
    v_mov_b32 v6, 0
    v_mov_b32 v7, 0
    v_readlane_b32 s20, v174, 63
    v_readlane_b32 s21, v175, 63
    s_nop 1
    v_mov_b32 v6, s20
    v_mov_b32 v7, s21
    s_nop 1
    v_mov_b32_dpp v6, v178 wave_shr:1 row_mask:0xf bank_mask:0xf
    v_mov_b32_dpp v7, v179 wave_shr:1 row_mask:0xf bank_mask:0xf
    v_alignbit_b32 v100, v176, v7, 16
    v_alignbit_b32 v101, v177, v176, 16
    v_alignbit_b32 v102, v178, v177, 16
    v_alignbit_b32 v103, v179, v178, 16
    v_mov_b32 v104, v7
    v_mov_b32 v105, v176
    v_mov_b32 v106, v177
    v_mov_b32 v107, v178
    v_alignbit_b32 v108, v7, v6, 16
    v_mov_b32 v109, v100
    v_mov_b32 v110, v101
    v_mov_b32 v111, v102
    v_lshl_add_u32 v4, v0, 4, s41
    ds_write_b128 v4, v[164:167] offset:32
    ds_write_b128 v4, v[64:67] offset:8224
    ds_write_b128 v4, v[68:71] offset:16416
    ds_write_b128 v4, v[72:75] offset:24608
    ds_write_b128 v4, v[168:171] offset:1056
    ds_write_b128 v4, v[76:79] offset:9248
    ds_write_b128 v4, v[80:83] offset:17440
    ds_write_b128 v4, v[84:87] offset:25632
    ds_write_b128 v4, v[172:175] offset:2080
    ds_write_b128 v4, v[88:91] offset:10272
    ds_write_b128 v4, v[92:95] offset:18464
    ds_write_b128 v4, v[96:99] offset:26656
    ds_write_b128 v4, v[176:179] offset:3104
    ds_write_b128 v4, v[100:103] offset:11296
    ds_write_b128 v4, v[104:107] offset:19488
    ds_write_b128 v4, v[108:111] offset:27680
    v_mov_b32 v6, 0
    v_mov_b32 v7, 0
    v_lshl_add_u32 v4, v0, 3, s41
    s_mov_b32 exec_lo, 0xf
    s_mov_b32 exec_hi, 0x0
    ds_write_b64 v4, v[6:7] offset:0
    ds_write_b64 v4, v[6:7] offset:8192
    ds_write_b64 v4, v[6:7] offset:16384
    ds_write_b64 v4, v[6:7] offset:24576
    s_mov_b64 exec, -1
L_spk:
    s_lshr_b32 s21, s3, 5
    v_mul_u32_u24 v8, 18, v0
    v_add_u32 v8, s21, v8
    v_and_b32 v9, 31, v8
    v_add_u32 v9, 224, v9
    v_cmp_gt_u32 vcc, 256, v8
    v_subrev_u32 v8, 256, v8
    v_lshrrev_b32 v8, 2, v8
    v_cndmask_b32 v8, v8, v9, vcc
    v_lshlrev_b32 v8, 7, v8
    s_mov_b32 s22, 14163968
    s_mov_b32 s97, 40000
fspin_42:
    buffer_load_dwordx2 v[10:11], v8, s[36:39], s22 offen sc0 sc1
    s_waitcnt vmcnt(0)
    v_cmp_ne_u64 vcc, s[88:89], v[10:11]
    s_cbranch_vccz fdone_43
    s_sleep 6
    s_sub_u32 s97, s97, 1
    s_cbranch_scc0 fspin_42
fdone_43:
    v_sub_u32 v4, 63, v0
    v_lshlrev_b32 v4, 6, v4
    s_lshl_b32 s21, s3, 12
    s_add_u32 s21, s21, 7077888
    s_mov_b32 s23, s92
    s_lshl_b32 s20, s95, 4
    s_add_u32 s21, s21, s20
    s_mul_i32 s20, s95, 1216
    s_add_u32 s23, s23, s20
    v_lshl_add_u32 v5, v0, 1, s23
    v_mov_b32 v6, 0
    s_add_u32 m0, s23, 0
    ds_write_b16 v5, v6 offset:1024
    buffer_load_dwordx4 v4, s[36:39], s21 offen sc1 lds
    s_add_u32 s21, s21, 16
    v_sub_u32 v4, 63, v0
    v_lshlrev_b32 v4, 6, v4
    s_lshl_b32 s21, s56, 12
    s_add_u32 s21, s21, 7077888
    s_mov_b32 s23, s101
    s_lshl_b32 s20, s95, 4
    s_add_u32 s21, s21, s20
    s_mul_i32 s20, s95, 1216
    s_add_u32 s23, s23, s20
    v_lshl_add_u32 v5, v0, 1, s23
    v_mov_b32 v6, 0
    s_add_u32 m0, s23, 0
    ds_write_b16 v5, v6 offset:1024
    buffer_load_dwordx4 v4, s[36:39], s21 offen sc1 lds
    s_add_u32 s21, s21, 16
    s_waitcnt vmcnt(0) lgkmcnt(0)
    s_barrier
L_conv:
    s_load_dwordx2 s[6:7], s[0:1], 64
    s_lshl_b32 s20, s3, 12
    s_mul_i32 s23, s95, 1216
    s_add_u32 s23, s23, s92
    v_lshlrev_b32 v13, 4, v0
    v_add_u32 v14, s91, v13
    v_lshrrev_b32 v7, 4, v0
    v_bfe_u32 v8, v0, 2, 2
    v_and_b32 v9, 3, v0
    v_lshlrev_b32 v10, 3, v7
    v_add3_u32 v10, v10, v8, v9
    v_lshl_add_u32 v10, v10, 3, s91
    v_and_b32 v11, 15, v0
    v_lshlrev_b32 v12, 4, v7
    v_lshlrev_b32 v8, 3, v11
    v_sub_u32 v12, v12, v8
    v_add_u32 v12, 120, v12
    v_add_u32 v12, s23, v12
    s_lshr_b32 s21, s3, 1
    s_lshl_b32 s21, s21, 2
    s_waitcnt lgkmcnt(0)
    s_load_dword s24, s[6:7], s21
    ds_read_b64_tr_b16 v[16:17], v10 offset:8
    ds_read_b64_tr_b16 v[18:19], v10 offset:40
    ds_read_b64 v[112:113], v12 offset:0
    ds_read_b64 v[114:115], v12 offset:8
    ds_read_b64 v[116:117], v12 offset:960
    ds_read_b64 v[118:119], v12 offset:968
    ds_read_b64_tr_b16 v[20:21], v10 offset:264
    ds_read_b64_tr_b16 v[22:23], v10 offset:296
    ds_read_b64_tr_b16 v[28:29], v10 offset:776
    ds_read_b64_tr_b16 v[30:31], v10 offset:808
    ds_read_b64_tr_b16 v[36:37], v10 offset:1288
    ds_read_b64_tr_b16 v[38:39], v10 offset:1320
    ds_read_b64_tr_b16 v[44:45], v10 offset:1800
    ds_read_b64_tr_b16 v[46:47], v10 offset:1832
    ds_read_b64 v[120:121], v12 offset:64
    ds_read_b64 v[122:123], v12 offset:72
    s_waitcnt lgkmcnt(12)
    v_mfma_f32_16x16x32_bf16 v[108:111], v[16:19], v[112:115], 0
    ds_read_b64_tr_b16 v[52:53], v10 offset:2312
    ds_read_b64_tr_b16 v[54:55], v10 offset:2344
    ds_read_b64_tr_b16 v[60:61], v10 offset:2824
    ds_read_b64_tr_b16 v[62:63], v10 offset:2856
    ds_read_b64 v[124:125], v12 offset:896
    ds_read_b64 v[126:127], v12 offset:904
    s_waitcnt lgkmcnt(15)
    s_waitcnt lgkmcnt(14)
    v_mfma_f32_16x16x32_bf16 v[80:83], v[20:23], v[116:119], 0
    ds_read_b64_tr_b16 v[68:69], v10 offset:3336
    ds_read_b64_tr_b16 v[70:71], v10 offset:3368
    s_waitcnt lgkmcnt(14)
    v_mfma_f32_16x16x32_bf16 v[84:87], v[28:31], v[116:119], 0
    ds_read_b64_tr_b16 v[76:77], v10 offset:3848
    ds_read_b64_tr_b16 v[78:79], v10 offset:3880
    s_waitcnt lgkmcnt(14)
    v_mfma_f32_16x16x32_bf16 v[88:91], v[36:39], v[116:119], 0
    ds_read_b64_tr_b16 v[24:25], v10 offset:520
    ds_read_b64_tr_b16 v[26:27], v10 offset:552
    s_waitcnt lgkmcnt(14)
    v_mfma_f32_16x16x32_bf16 v[92:95], v[44:47], v[116:119], 0
    ds_read_b64_tr_b16 v[32:33], v10 offset:1032
    ds_read_b64_tr_b16 v[34:35], v10 offset:1064
    s_waitcnt lgkmcnt(12)
    v_mfma_f32_16x16x32_bf16 v[96:99], v[52:55], v[116:119], 0
    ds_read_b64_tr_b16 v[40:41], v10 offset:1544
    ds_read_b64_tr_b16 v[42:43], v10 offset:1576
    s_waitcnt lgkmcnt(12)
    v_mfma_f32_16x16x32_bf16 v[100:103], v[60:63], v[116:119], 0
    ds_read_b64_tr_b16 v[48:49], v10 offset:2056
    ds_read_b64_tr_b16 v[50:51], v10 offset:2088
    s_waitcnt lgkmcnt(10)
    v_mfma_f32_16x16x32_bf16 v[104:107], v[68:71], v[116:119], 0
    ds_read_b64_tr_b16 v[56:57], v10 offset:2568
    ds_read_b64_tr_b16 v[58:59], v10 offset:2600
    s_waitcnt lgkmcnt(10)
    v_mfma_f32_16x16x32_bf16 v[108:111], v[76:79], v[116:119], v[108:111]
    ds_read_b64_tr_b16 v[64:65], v10 offset:3080
    ds_read_b64_tr_b16 v[66:67], v10 offset:3112
    ds_read_b64 v[112:113], v12 offset:128
    ds_read_b64 v[114:115], v12 offset:136
    v_mfma_f32_16x16x32_bf16 v[108:111], v[20:23], v[120:123], v[108:111]
    ds_read_b64_tr_b16 v[72:73], v10 offset:3592
    ds_read_b64_tr_b16 v[74:75], v10 offset:3624
    ds_read_b64 v[116:117], v12 offset:832
    ds_read_b64 v[118:119], v12 offset:840
    v_mfma_f32_16x16x32_bf16 v[80:83], v[16:19], v[124:127], v[80:83]
    s_waitcnt lgkmcnt(15)
    v_mfma_f32_16x16x32_bf16 v[84:87], v[24:27], v[124:127], v[84:87]
    s_waitcnt lgkmcnt(14)
    v_mfma_f32_16x16x32_bf16 v[88:91], v[32:35], v[124:127], v[88:91]
    s_waitcnt lgkmcnt(12)
    v_mfma_f32_16x16x32_bf16 v[92:95], v[40:43], v[124:127], v[92:95]
    s_waitcnt lgkmcnt(10)
    v_mfma_f32_16x16x32_bf16 v[96:99], v[48:51], v[124:127], v[96:99]
    s_waitcnt lgkmcnt(8)
    v_mfma_f32_16x16x32_bf16 v[100:103], v[56:59], v[124:127], v[100:103]
    s_waitcnt lgkmcnt(6)
    v_mfma_f32_16x16x32_bf16 v[104:107], v[64:67], v[124:127], v[104:107]
    s_waitcnt lgkmcnt(2)
    v_mfma_f32_16x16x32_bf16 v[108:111], v[72:75], v[124:127], v[108:111]
    ds_read_b64 v[120:121], v12 offset:192
    ds_read_b64 v[122:123], v12 offset:200
    v_mfma_f32_16x16x32_bf16 v[104:107], v[16:19], v[112:115], v[104:107]
    v_mfma_f32_16x16x32_bf16 v[108:111], v[24:27], v[112:115], v[108:111]
    ds_read_b64 v[124:125], v12 offset:768
    ds_read_b64 v[126:127], v12 offset:776
    s_waitcnt lgkmcnt(4)
    v_mfma_f32_16x16x32_bf16 v[84:87], v[20:23], v[116:119], v[84:87]
    v_mfma_f32_16x16x32_bf16 v[88:91], v[28:31], v[116:119], v[88:91]
    v_mfma_f32_16x16x32_bf16 v[92:95], v[36:39], v[116:119], v[92:95]
    v_mfma_f32_16x16x32_bf16 v[96:99], v[44:47], v[116:119], v[96:99]
    v_mfma_f32_16x16x32_bf16 v[100:103], v[52:55], v[116:119], v[100:103]
    v_mfma_f32_16x16x32_bf16 v[104:107], v[60:63], v[116:119], v[104:107]
    v_mfma_f32_16x16x32_bf16 v[108:111], v[68:71], v[116:119], v[108:111]
    ds_read_b64 v[112:113], v12 offset:256
    ds_read_b64 v[114:115], v12 offset:264
    s_waitcnt lgkmcnt(4)
    v_mfma_f32_16x16x32_bf16 v[104:107], v[20:23], v[120:123], v[104:107]
    v_mfma_f32_16x16x32_bf16 v[108:111], v[28:31], v[120:123], v[108:111]
    ds_read_b64 v[116:117], v12 offset:704
    ds_read_b64 v[118:119], v12 offset:712
    s_waitcnt lgkmcnt(4)
    v_mfma_f32_16x16x32_bf16 v[84:87], v[16:19], v[124:127], v[84:87]
    v_mfma_f32_16x16x32_bf16 v[88:91], v[24:27], v[124:127], v[88:91]
    v_mfma_f32_16x16x32_bf16 v[92:95], v[32:35], v[124:127], v[92:95]
    v_mfma_f32_16x16x32_bf16 v[96:99], v[40:43], v[124:127], v[96:99]
    v_mfma_f32_16x16x32_bf16 v[100:103], v[48:51], v[124:127], v[100:103]
    v_mfma_f32_16x16x32_bf16 v[104:107], v[56:59], v[124:127], v[104:107]
    v_mfma_f32_16x16x32_bf16 v[108:111], v[64:67], v[124:127], v[108:111]
    ds_read_b64 v[120:121], v12 offset:320
    ds_read_b64 v[122:123], v12 offset:328
    s_waitcnt lgkmcnt(4)
    v_mfma_f32_16x16x32_bf16 v[100:103], v[16:19], v[112:115], v[100:103]
    v_mfma_f32_16x16x32_bf16 v[104:107], v[24:27], v[112:115], v[104:107]
    v_mfma_f32_16x16x32_bf16 v[108:111], v[32:35], v[112:115], v[108:111]
    ds_read_b64 v[124:125], v12 offset:640
    ds_read_b64 v[126:127], v12 offset:648
    s_waitcnt lgkmcnt(4)
    v_mfma_f32_16x16x32_bf16 v[88:91], v[20:23], v[116:119], v[88:91]
    v_mfma_f32_16x16x32_bf16 v[92:95], v[28:31], v[116:119], v[92:95]
    v_mfma_f32_16x16x32_bf16 v[96:99], v[36:39], v[116:119], v[96:99]
    v_mfma_f32_16x16x32_bf16 v[100:103], v[44:47], v[116:119], v[100:103]
    v_mfma_f32_16x16x32_bf16 v[104:107], v[52:55], v[116:119], v[104:107]
    v_mfma_f32_16x16x32_bf16 v[108:111], v[60:63], v[116:119], v[108:111]
    ds_read_b64 v[112:113], v12 offset:384
    ds_read_b64 v[114:115], v12 offset:392
    s_waitcnt lgkmcnt(4)
    v_mfma_f32_16x16x32_bf16 v[100:103], v[20:23], v[120:123], v[100:103]
    v_mfma_f32_16x16x32_bf16 v[104:107], v[28:31], v[120:123], v[104:107]
    v_mfma_f32_16x16x32_bf16 v[108:111], v[36:39], v[120:123], v[108:111]
    ds_read_b64 v[116:117], v12 offset:576
    ds_read_b64 v[118:119], v12 offset:584
    s_waitcnt lgkmcnt(4)
    v_mfma_f32_16x16x32_bf16 v[88:91], v[16:19], v[124:127], v[88:91]
    v_mfma_f32_16x16x32_bf16 v[92:95], v[24:27], v[124:127], v[92:95]
    v_mfma_f32_16x16x32_bf16 v[96:99], v[32:35], v[124:127], v[96:99]
    v_mfma_f32_16x16x32_bf16 v[100:103], v[40:43], v[124:127], v[100:103]
    v_mfma_f32_16x16x32_bf16 v[104:107], v[48:51], v[124:127], v[104:107]
    v_mfma_f32_16x16x32_bf16 v[108:111], v[56:59], v[124:127], v[108:111]
    ds_read_b64 v[120:121], v12 offset:448
    ds_read_b64 v[122:123], v12 offset:456
    s_waitcnt lgkmcnt(4)
    v_mfma_f32_16x16x32_bf16 v[96:99], v[16:19], v[112:115], v[96:99]
    v_mfma_f32_16x16x32_bf16 v[100:103], v[24:27], v[112:115], v[100:103]
    v_mfma_f32_16x16x32_bf16 v[104:107], v[32:35], v[112:115], v[104:107]
    v_mfma_f32_16x16x32_bf16 v[108:111], v[40:43], v[112:115], v[108:111]
    ds_read_b64 v[124:125], v12 offset:512
    ds_read_b64 v[126:127], v12 offset:520
    s_waitcnt lgkmcnt(4)
    v_mfma_f32_16x16x32_bf16 v[92:95], v[20:23], v[116:119], v[92:95]
    v_mfma_f32_16x16x32_bf16 v[96:99], v[28:31], v[116:119], v[96:99]
    v_mfma_f32_16x16x32_bf16 v[100:103], v[36:39], v[116:119], v[100:103]
    v_mfma_f32_16x16x32_bf16 v[104:107], v[44:47], v[116:119], v[104:107]
    v_mfma_f32_16x16x32_bf16 v[108:111], v[52:55], v[116:119], v[108:111]
    s_waitcnt lgkmcnt(2)
    v_mfma_f32_16x16x32_bf16 v[96:99], v[20:23], v[120:123], v[96:99]
    v_mfma_f32_16x16x32_bf16 v[100:103], v[28:31], v[120:123], v[100:103]
    v_mfma_f32_16x16x32_bf16 v[104:107], v[36:39], v[120:123], v[104:107]
    v_mfma_f32_16x16x32_bf16 v[108:111], v[44:47], v[120:123], v[108:111]
    s_waitcnt lgkmcnt(0)
    v_mfma_f32_16x16x32_bf16 v[92:95], v[16:19], v[124:127], v[92:95]
    v_mfma_f32_16x16x32_bf16 v[96:99], v[24:27], v[124:127], v[96:99]
    v_mfma_f32_16x16x32_bf16 v[100:103], v[32:35], v[124:127], v[100:103]
    v_mfma_f32_16x16x32_bf16 v[104:107], v[40:43], v[124:127], v[104:107]
    v_mfma_f32_16x16x32_bf16 v[108:111], v[48:51], v[124:127], v[108:111]
    s_lshl_b32 s21, s95, 13
    s_sub_u32 s22, s91, s21
    s_lshl_b32 s21, s95, 11
    s_add_u32 s22, s22, s21
    v_add_u32 v15, s22, v13
    v_mov_b32 v48, 0
    v_mov_b32 v49, 0
    v_mov_b32 v50, 0
    v_mov_b32 v51, 0
    v_mov_b32 v52, 0
    v_mov_b32 v53, 0
    v_mov_b32 v54, 0
    v_mov_b32 v55, 0
    ds_write_b128 v14, v[80:83] offset:0
    ds_write_b128 v14, v[84:87] offset:1024
    ds_write_b128 v14, v[88:91] offset:2048
    ds_write_b128 v14, v[92:95] offset:3072
    ds_write_b128 v14, v[96:99] offset:4096
    ds_write_b128 v14, v[100:103] offset:5120
    ds_write_b128 v14, v[104:107] offset:6144
    ds_write_b128 v14, v[108:111] offset:7168
    v_lshl_add_u32 v13, v11, 2, v7
    v_lshlrev_b32 v13, 1, v13
    v_sub_u32 v13, 894, v13
    s_lshl_b32 s21, s95, 8
    s_sub_u32 s21, s92, s21
    v_add_u32 v13, s21, v13
    v_lshlrev_b32 v14, 5, v11
    v_lshl_add_u32 v14, v7, 3, v14
    s_lshl_b32 s21, s95, 10
    s_add_u32 s21, s21, s20
    s_add_u32 s21, s21, 11796480
    v_mov_b32 v1, s93
    v_mov_b32 v2, 1
    s_add_u32 s96, s96, 4
    s_waitcnt lgkmcnt(0)
    s_mov_b64 exec, 1
    ds_add_u32 v1, v2
    s_mov_b64 exec, -1
    s_mov_b32 s97, 320000
gb_44:
    ds_read_b32 v2, v1
    s_sub_u32 s97, s97, 1
    s_cbranch_scc1 gbd_45
    s_waitcnt lgkmcnt(0)
    v_readfirstlane_b32 s22, v2
    s_cmp_ge_u32 s22, s96
    s_cbranch_scc1 gbd_45
    s_sleep 1
    s_branch gb_44
gbd_45:
    s_waitcnt lgkmcnt(0)
    s_lshl_b32 s25, s24, 16
    s_and_b32 s24, s24, 0xffff0000
    s_bitcmp1_b32 s3, 0
    s_cselect_b32 s24, s24, s25
    ds_read_b128 v[16:19], v15 offset:0
    ds_read_b128 v[20:23], v15 offset:8192
    ds_read_b128 v[24:27], v15 offset:16384
    ds_read_b128 v[28:31], v15 offset:24576
    ds_read_u16_d16_hi v48, v13 offset:128
    ds_read_u16_d16_hi v49, v13 offset:1344
    ds_read_u16_d16_hi v50, v13 offset:2560
    ds_read_u16_d16_hi v51, v13 offset:3776
    ds_read_b128 v[32:35], v15 offset:1024
    ds_read_b128 v[36:39], v15 offset:9216
    ds_read_b128 v[40:43], v15 offset:17408
    ds_read_b128 v[44:47], v15 offset:25600
    ds_read_u16_d16_hi v52, v13 offset:0
    ds_read_u16_d16_hi v53, v13 offset:1216
    ds_read_u16_d16_hi v54, v13 offset:2432
    ds_read_u16_d16_hi v55, v13 offset:3648
    s_waitcnt lgkmcnt(8)
    v_add_f32 v16, v16, v20
    v_add_f32 v17, v17, v21
    v_add_f32 v18, v18, v22
    v_add_f32 v19, v19, v23
    v_add_f32 v24, v24, v28
    v_add_f32 v25, v25, v29
    v_add_f32 v26, v26, v30
    v_add_f32 v27, v27, v31
    v_mul_f32 v48, s24, v48
    v_mul_f32 v49, s24, v49
    v_mul_f32 v50, s24, v50
    v_mul_f32 v51, s24, v51
    v_add_f32 v16, v16, v24
    v_add_f32 v17, v17, v25
    v_add_f32 v18, v18, v26
    v_add_f32 v19, v19, v27
    v_cvt_pk_bf16_f32 v48, 0, v48
    v_cvt_pk_bf16_f32 v49, 0, v49
    v_cvt_pk_bf16_f32 v50, 0, v50
    v_cvt_pk_bf16_f32 v51, 0, v51
    v_cvt_pk_bf16_f32 v16, 0, v16
    v_cvt_pk_bf16_f32 v17, 0, v17
    v_cvt_pk_bf16_f32 v18, 0, v18
    v_cvt_pk_bf16_f32 v19, 0, v19
    v_add_f32 v16, v16, v48
    v_add_f32 v17, v17, v49
    v_add_f32 v18, v18, v50
    v_add_f32 v19, v19, v51
    v_cvt_pk_bf16_f32 v16, v16, v17
    v_cvt_pk_bf16_f32 v17, v18, v19
    buffer_store_dwordx2 v[16:17], v14, s[36:39], s21 offen offset:0 sc1
    s_waitcnt lgkmcnt(0)
    v_add_f32 v32, v32, v36
    v_add_f32 v33, v33, v37
    v_add_f32 v34, v34, v38
    v_add_f32 v35, v35, v39
    v_add_f32 v40, v40, v44
    v_add_f32 v41, v41, v45
    v_add_f32 v42, v42, v46
    v_add_f32 v43, v43, v47
    v_mul_f32 v52, s24, v52
    v_mul_f32 v53, s24, v53
    v_mul_f32 v54, s24, v54
    v_mul_f32 v55, s24, v55
    v_add_f32 v32, v32, v40
    v_add_f32 v33, v33, v41
    v_add_f32 v34, v34, v42
    v_add_f32 v35, v35, v43
    v_cvt_pk_bf16_f32 v52, 0, v52
    v_cvt_pk_bf16_f32 v53, 0, v53
    v_cvt_pk_bf16_f32 v54, 0, v54
    v_cvt_pk_bf16_f32 v55, 0, v55
    v_cvt_pk_bf16_f32 v32, 0, v32
    v_cvt_pk_bf16_f32 v33, 0, v33
    v_cvt_pk_bf16_f32 v34, 0, v34
    v_cvt_pk_bf16_f32 v35, 0, v35
    v_add_f32 v32, v32, v52
    v_add_f32 v33, v33, v53
    v_add_f32 v34, v34, v54
    v_add_f32 v35, v35, v55
    v_cvt_pk_bf16_f32 v32, v32, v33
    v_cvt_pk_bf16_f32 v33, v34, v35
    buffer_store_dwordx2 v[32:33], v14, s[36:39], s21 offen offset:512 sc1
    s_sub_u32 s94, s94, 1
    s_cmp_eq_u32 s94, 0
    s_cbranch_scc1 L_attn
    s_add_u32 s3, s3, 2
    s_mov_b32 s91, s100
    s_mov_b32 s92, s101
    s_branch L_conv
L_attn:
    s_and_b32 s22, s2, 7
    s_lshl_b32 s22, s22, 1
    s_bfe_u32 s19, s2, 0x10003
    s_add_u32 s40, s22, s19
    s_lshr_b32 s41, s2, 4
    s_lshr_b32 s23, s18, 2
    s_mul_i32 s24, s40, 9
    s_sub_i32 s32, s41, 2
    s_max_i32 s32, s32, 0
    s_sub_i32 s33, s41, 1
    s_max_i32 s33, s33, 0
    s_sub_i32 s34, s41, 0
    s_max_i32 s34, s34, 0
    s_cmp_ge_u32 s18, 4
    s_cbranch_scc1 L_nostage
    v_lshrrev_b32 v1, 3, v0
    v_min_u32 v1, 2, v1
    v_mul_u32_u24 v1, 144, v1
    v_bfe_u32 v2, v0, 2, 1
    v_lshl_add_u32 v1, v2, 3, v1
    v_add_u32 v1, s24, v1
    v_lshrrev_b32 v1, 5, v1
    v_and_b32 v2, 3, v0
    v_min_u32 v2, 2, v2
    v_sub_u32 v2, s41, v2
    v_max_i32 v2, 0, v2
    v_cmp_lt_u32 vcc, 6, v1
    v_subrev_u32 v3, 7, v1
    v_lshrrev_b32 v4, 2, v2
    v_cndmask_b32 v1, v1, v3, vcc
    v_add_u32 v3, 4, v4
    v_cndmask_b32 v4, v4, v3, vcc
    v_and_b32 v2, 3, v2
    v_lshl_add_u32 v1, v1, 2, v2
    v_lshl_add_u32 v1, v1, 3, v4
    s_lshl_b32 s32, s32, 10
    s_lshl_b32 s33, s33, 10
    s_lshl_b32 s34, s34, 10
    s_add_u32 s26, s24, s18
    s_lshl_b32 s26, s26, 14
    s_mul_i32 s27, s18, 3104
    s_lshl_b32 s28, s18, 10
    s_add_u32 s29, s24, 8
    s_lshl_b32 s29, s29, 14
    s_add_u32 s48, s34, 0
    s_mov_b32 s49, 18432
    s_add_u32 s19, s34, 2359296
    s_cmp_eq_u32 s18, 1
    s_cselect_b32 s48, s19, s48
    s_cselect_b32 s49, 51456, s49
    s_add_u32 s19, s34, 4718592
    s_cmp_eq_u32 s18, 2
    s_cselect_b32 s48, s19, s48
    s_cselect_b32 s49, 162784, s49
    s_add_u32 s19, s33, 2359296
    s_cmp_eq_u32 s18, 3
    s_cselect_b32 s48, s19, s48
    s_cselect_b32 s49, 50432, s49
    s_add_u32 s48, s48, s29
    s_add_u32 s50, s33, 4718592
    s_mov_b32 s51, 161760
    s_add_u32 s19, s32, 2359296
    s_cmp_eq_u32 s18, 1
    s_cselect_b32 s50, s19, s50
    s_cselect_b32 s51, 49408, s51
    s_add_u32 s19, s32, 4718592
    s_cmp_eq_u32 s18, 2
    s_cselect_b32 s50, s19, s50
    s_cselect_b32 s51, 160736, s51
    s_add_u32 s19, s32, 4718592
    s_cmp_eq_u32 s18, 3
    s_cselect_b32 s50, s19, s50
    s_cselect_b32 s51, 160736, s51
    s_add_u32 s50, s50, s29
    s_cmp_lg_u32 s18, 0
    s_cbranch_scc1 L_w2_o
    v_lshlrev_b32 v1, 7, v1
    s_mov_b32 s22, 14163976
    s_mov_b32 s97, 40000
fspin_46:
    buffer_load_dwordx2 v[2:3], v1, s[36:39], s22 offen sc0 sc1
    s_waitcnt vmcnt(0)
    v_cmp_ne_u64 vcc, s[88:89], v[2:3]
    s_cbranch_vccz fdone_47
    s_sleep 2
    s_sub_u32 s97, s97, 1
    s_cbranch_scc0 fspin_46
fdone_47:
    v_mov_b32 v2, 22052
    v_mov_b32 v3, 1
    ds_write_b32 v2, v3
    s_branch L_w2_j
L_w2_o:
    v_mov_b32 v2, 22052
    s_mov_b32 s97, 320000
gb_48:
    ds_read_b32 v3, v2
    s_sub_u32 s97, s97, 1
    s_cbranch_scc1 gbd_49
    s_waitcnt lgkmcnt(0)
    v_readfirstlane_b32 s22, v3
    s_cmp_ge_u32 s22, 1
    s_cbranch_scc1 gbd_49
    s_sleep 1
    s_branch gb_48
gbd_49:
    s_waitcnt lgkmcnt(0)
L_w2_j:
    s_cmp_eq_u32 s90, 0
    s_cselect_b32 s19, 8, 4
    s_cselect_b32 s20, 4, 8
    s_add_u32 s19, s19, 22016
    v_mov_b32 v1, s19
    s_mov_b32 s97, 320000
gb_50:
    ds_read_b32 v2, v1
    s_sub_u32 s97, s97, 1
    s_cbranch_scc1 gbd_51
    s_waitcnt lgkmcnt(0)
    v_readfirstlane_b32 s22, v2
    s_cmp_ge_u32 s22, s20
    s_cbranch_scc1 gbd_51
    s_sleep 1
    s_branch gb_50
gbd_51:
    s_waitcnt lgkmcnt(0)
    v_lshlrev_b32 v2, 4, v0
    s_add_u32 m0, s28, 10240
    s_add_u32 s35, s26, s34
    s_add_u32 s35, s35, 0
    buffer_load_dwordx4 v2, s[36:39], s35 offen sc1 lds
    s_add_u32 m0, s28, 14336
    s_add_u32 s35, s26, s34
    s_add_u32 s35, s35, 65536
    buffer_load_dwordx4 v2, s[36:39], s35 offen sc1 lds
    s_add_u32 m0, s27, 26624
    s_add_u32 s35, s26, s34
    s_add_u32 s35, s35, 2359296
    buffer_load_dwordx4 v2, s[36:39], s35 offen sc1 lds
    s_add_u32 m0, s27, 39040
    s_add_u32 s35, s26, s34
    s_add_u32 s35, s35, 2424832
    buffer_load_dwordx4 v2, s[36:39], s35 offen sc1 lds
    s_add_u32 m0, s27, 137952
    s_add_u32 s35, s26, s34
    s_add_u32 s35, s35, 4718592
    buffer_load_dwordx4 v2, s[36:39], s35 offen sc1 lds
    s_add_u32 m0, s27, 150368
    s_add_u32 s35, s26, s34
    s_add_u32 s35, s35, 4784128
    buffer_load_dwordx4 v2, s[36:39], s35 offen sc1 lds
    s_mov_b32 m0, s49
    s_nop 0
    buffer_load_dwordx4 v2, s[36:39], s48 offen sc1 lds
    s_add_u32 m0, s27, 25600
    s_add_u32 s35, s26, s33
    s_add_u32 s35, s35, 2359296
    buffer_load_dwordx4 v2, s[36:39], s35 offen sc1 lds
    s_add_u32 m0, s27, 38016
    s_add_u32 s35, s26, s33
    s_add_u32 s35, s35, 2424832
    buffer_load_dwordx4 v2, s[36:39], s35 offen sc1 lds
    s_add_u32 m0, s27, 136928
    s_add_u32 s35, s26, s33
    s_add_u32 s35, s35, 4718592
    buffer_load_dwordx4 v2, s[36:39], s35 offen sc1 lds
    s_add_u32 m0, s27, 149344
    s_add_u32 s35, s26, s33
    s_add_u32 s35, s35, 4784128
    buffer_load_dwordx4 v2, s[36:39], s35 offen sc1 lds
    s_add_u32 m0, s27, 24576
    s_add_u32 s35, s26, s32
    s_add_u32 s35, s35, 2359296
    buffer_load_dwordx4 v2, s[36:39], s35 offen sc1 lds
    s_add_u32 m0, s27, 36992
    s_add_u32 s35, s26, s32
    s_add_u32 s35, s35, 2424832
    buffer_load_dwordx4 v2, s[36:39], s35 offen sc1 lds
    s_mov_b32 m0, s51
    s_nop 0
    buffer_load_dwordx4 v2, s[36:39], s50 offen sc1 lds
    s_add_u32 m0, s27, 135904
    s_add_u32 s35, s26, s32
    s_add_u32 s35, s35, 4718592
    buffer_load_dwordx4 v2, s[36:39], s35 offen sc1 lds
    s_add_u32 m0, s27, 148320
    s_add_u32 s35, s26, s32
    s_add_u32 s35, s35, 4784128
    buffer_load_dwordx4 v2, s[36:39], s35 offen sc1 lds
    v_mov_b32 v5, 0x3f803f80
    v_lshlrev_b32 v6, 2, v0
    s_lshl_b32 s35, s18, 8
    v_add_u32 v6, s35, v6
    ds_write_b32 v6, v5 offset:52512
    ds_write_b32 v6, v5 offset:53536
    ds_write_b32 v6, v5 offset:54560
L_nostage:
    v_and_b32 v1, 31, v0
    v_lshrrev_b32 v15, 5, v0
    s_lshl_b32 s46, s41, 2
    s_add_u32 s46, s46, s95
    v_lshlrev_b32 v3, 3, v1
    s_mul_i32 s25, s23, 5
    s_lshl_b32 s35, s95, 8
    s_lshl_b32 s26, s25, 10
    s_add_u32 s26, s26, s35
    s_add_u32 s26, s26, 10240
    v_lshl_add_u32 v108, v15, 11, v3
    v_add_u32 v108, s26, v108
    s_add_u32 s26, s35, 14336
    v_add_u32 v109, s26, v3
    s_lshl_b32 s35, s95, 8
    s_mul_i32 s25, s25, 3104
    s_add_u32 s26, s25, s35
    s_add_u32 s26, s26, 24576
    v_mul_u32_u24 v4, 6208, v15
    v_add3_u32 v4, v4, v3, s26
    v_mul_u32_u24 v5, 15520, v15
    s_add_u32 s26, s35, 36992
    v_add3_u32 v3, v5, v3, s26
    v_bfe_u32 v5, v0, 2, 2
    v_lshl_add_u32 v5, v15, 2, v5
    v_lshlrev_b32 v5, 3, v5
    v_and_b32 v6, 3, v0
    v_mul_u32_u24 v7, 3104, v6
    s_add_u32 s26, s25, 135904
    v_add_u32 v7, s26, v7
    v_mov_b32 v2, 148320
    s_mov_b32 s20, 0x11110000
    s_mov_b32 s21, s20
    v_cndmask_b32 v7, v7, v2, s[20:21]
    v_mov_b32 v2, 52512
    s_mov_b32 s20, 0xeeee0000
    s_mov_b32 s21, s20
    v_cndmask_b32 v7, v7, v2, s[20:21]
    v_add3_u32 v5, v5, v7, s35
    s_sub_i32 s27, 8, s46
    s_max_i32 s27, s27, 0
    v_mov_b32 v2, 0xff800000
    s_mov_b32 s20, 0xffffffff
    s_mov_b32 s21, 0xfffffff0
    v_cndmask_b32 v44, v2, 0, s[20:21]
    s_mov_b32 s20, 0xfffffffe
    s_mov_b32 s21, 0xffffffe0
    v_cndmask_b32 v45, v2, 0, s[20:21]
    s_mov_b32 s20, 0xfffffffc
    s_mov_b32 s21, 0xffffffc0
    v_cndmask_b32 v46, v2, 0, s[20:21]
    s_mov_b32 s20, 0xfffffff8
    s_mov_b32 s21, 0xffffff80
    v_cndmask_b32 v47, v2, 0, s[20:21]
    s_mov_b32 s20, 0xffffff00
    s_mov_b32 s21, 0xfffff000
    v_cndmask_b32 v48, v2, 0, s[20:21]
    s_mov_b32 s20, 0xfffffe00
    s_mov_b32 s21, 0xffffe000
    v_cndmask_b32 v49, v2, 0, s[20:21]
    s_mov_b32 s20, 0xfffffc00
    s_mov_b32 s21, 0xffffc000
    v_cndmask_b32 v50, v2, 0, s[20:21]
    s_mov_b32 s20, 0xfffff800
    s_mov_b32 s21, 0xffff8000
    v_cndmask_b32 v51, v2, 0, s[20:21]
    s_mov_b32 s20, 0xffff0000
    s_mov_b32 s21, 0xfff00000
    v_cndmask_b32 v52, v2, 0, s[20:21]
    s_mov_b32 s20, 0xfffe0000
    s_mov_b32 s21, 0xffe00000
    v_cndmask_b32 v53, v2, 0, s[20:21]
    s_mov_b32 s20, 0xfffc0000
    s_mov_b32 s21, 0xffc00000
    v_cndmask_b32 v54, v2, 0, s[20:21]
    s_mov_b32 s20, 0xfff80000
    s_mov_b32 s21, 0xff800000
    v_cndmask_b32 v55, v2, 0, s[20:21]
    s_mov_b32 s20, 0xff000000
    s_mov_b32 s21, 0xf0000000
    v_cndmask_b32 v56, v2, 0, s[20:21]
    s_mov_b32 s20, 0xfe000000
    s_mov_b32 s21, 0xe0000000
    v_cndmask_b32 v57, v2, 0, s[20:21]
    s_mov_b32 s20, 0xfc000000
    s_mov_b32 s21, 0xc0000000
    v_cndmask_b32 v58, v2, 0, s[20:21]
    s_mov_b32 s20, 0xf8000000
    s_mov_b32 s21, 0x80000000
    v_cndmask_b32 v59, v2, 0, s[20:21]
    v_xor_b32 v144, v2, v44
    v_xor_b32 v145, v2, v45
    v_xor_b32 v146, v2, v46
    v_xor_b32 v147, v2, v47
    v_xor_b32 v148, v2, v48
    v_xor_b32 v149, v2, v49
    v_xor_b32 v150, v2, v50
    v_xor_b32 v151, v2, v51
    v_xor_b32 v152, v2, v52
    v_xor_b32 v153, v2, v53
    v_xor_b32 v154, v2, v54
    v_xor_b32 v155, v2, v55
    v_xor_b32 v156, v2, v56
    v_xor_b32 v157, v2, v57
    v_xor_b32 v158, v2, v58
    v_xor_b32 v159, v2, v59
    s_cmp_eq_u32 s23, 0
    s_cselect_b32 s48, -1, 0
    s_mov_b32 s49, 0
    s_cselect_b32 s50, 0, -1
    s_mov_b32 s51, 0
    s_mov_b32 s42, 0
    s_mov_b32 s43, -1
    s_load_dwordx2 s[6:7], s[0:1], 16
    s_min_u32 s19, s2, 251
    s_mul_i32 s56, s19, 2341
    s_lshr_b32 s56, s56, 16
    s_lshl_b32 s57, s56, 7
    v_lshrrev_b32 v110, 3, v0
    v_and_b32 v111, 7, v0
    v_lshrrev_b32 v112, 1, v110
    v_lshlrev_b32 v112, 1, v112
    v_xor_b32 v111, v111, v112
    v_mul_u32_u24 v110, 1152, v110
    v_lshl_add_u32 v110, v111, 4, v110
    s_waitcnt vmcnt(0) lgkmcnt(0)
    s_barrier
    s_cmp_lg_u32 s18, 0
    s_cbranch_scc1 L_nf3
    s_lshl_b32 s22, s2, 7
    s_add_u32 s22, s22, 14163984
    v_mov_b32 v112, s22
    v_mov_b32 v114, s88
    v_mov_b32 v115, s89
    s_mov_b64 exec, 1
    buffer_store_dwordx2 v[114:115], v112, s[36:39], 0 offen sc0 sc1
    s_mov_b64 exec, -1
L_nf3:
    ds_read_b64 v[8:9], v108
    ds_read_b64 v[10:11], v108 offset:1024
    ds_read_b64 v[12:13], v109
    ds_read_b64 v[16:17], v4 offset:2048
    ds_read_b64 v[18:19], v4 offset:5152
    ds_read_b64 v[20:21], v3 offset:2048
    ds_read_b64 v[22:23], v4 offset:1792
    ds_read_b64 v[24:25], v4 offset:4896
    ds_read_b64 v[26:27], v3 offset:1792
    s_add_u32 s28, s6, s57
    s_addc_u32 s29, s7, 0
    s_sub_u32 s30, 663552, s57
    s_mov_b32 s31, 0x00020000
    s_mul_i32 s58, s18, 9216
    s_lshl_b32 s59, s18, 10
    s_waitcnt lgkmcnt(3)
    v_cndmask_b32 v12, 0, v12, s[48:49]
    v_cndmask_b32 v13, 0, v13, s[50:51]
    v_dot2_f32_bf16 v6, v8, v16, 0
    v_dot2_f32_bf16 v6, v9, v17, v6
    v_dot2_f32_bf16 v6, v10, v18, v6
    v_dot2_f32_bf16 v6, v11, v19, v6
    v_dot2_f32_bf16 v6, v12, v20, v6
    v_dot2_f32_bf16 v6, v13, v21, v6
    v_mfma_f32_32x32x16_bf16 v[44:59], v[16:19], v[8:11], v[44:59]
    s_nop 2
    v_mov_b32 v7, v6
    s_nop 1
    v_permlane32_swap_b32 v6, v7
    s_nop 1
    v_add_f32 v6, v6, v7
    v_sub_f32 v6, 0, v6
    v_cvt_pk_bf16_f32 v6, v6, 0
    v_cndmask_b32 v12, v12, v6, s[42:43]
    s_nop 1
    v_mfma_f32_32x32x8_bf16 v[44:59], v[20:21], v[12:13], v[44:59]
    ds_read_b64_tr_b16 v[28:29], v5 offset:2048
    ds_read_b64_tr_b16 v[30:31], v5 offset:2112
    ds_read_b64_tr_b16 v[32:33], v5 offset:2176
    ds_read_b64_tr_b16 v[34:35], v5 offset:2240
    s_cmp_lg_u32 s27, 8
    s_cbranch_scc1 sa_k7
    v_mov_b32 v6, 0xff7f
    v_cndmask_b32 v12, v12, v6, s[42:43]
sa_k7:
    s_nop 3
    s_waitcnt lgkmcnt(4)
    v_mfma_f32_32x32x16_bf16 v[60:75], v[22:25], v[8:11], 0
    v_exp_f32 v44, v44
    v_exp_f32 v45, v45
    v_exp_f32 v46, v46
    v_exp_f32 v47, v47
    v_cvt_pk_bf16_f32 v76, v44, v45
    v_exp_f32 v48, v48
    v_mfma_f32_32x32x8_bf16 v[60:75], v[26:27], v[12:13], v[60:75]
    ds_read_b64 v[16:17], v4 offset:1536
    ds_read_b64 v[18:19], v4 offset:4640
    ds_read_b64 v[20:21], v3 offset:1536
    s_cmp_lg_u32 s27, 7
    s_cbranch_scc1 sa_k6
    v_mov_b32 v6, 0xff7f
    v_cndmask_b32 v12, v12, v6, s[42:43]
sa_k6:
    v_exp_f32 v49, v49
    v_cvt_pk_bf16_f32 v77, v46, v47
    v_exp_f32 v50, v50
    v_exp_f32 v51, v51
    v_cvt_pk_bf16_f32 v78, v48, v49
    v_exp_f32 v52, v52
    v_exp_f32 v53, v53
    v_cvt_pk_bf16_f32 v79, v50, v51
    v_exp_f32 v54, v54
    v_exp_f32 v55, v55
    v_cvt_pk_bf16_f32 v80, v52, v53
    v_exp_f32 v56, v56
    ds_read_b64_tr_b16 v[36:37], v5 offset:1792
    ds_read_b64_tr_b16 v[38:39], v5 offset:1856
    ds_read_b64_tr_b16 v[40:41], v5 offset:1920
    ds_read_b64_tr_b16 v[42:43], v5 offset:1984
    s_add_u32 m0, s59, 55680
    s_nop 0
    buffer_load_dwordx4 v110, s[28:31], s58 offen lds
    s_add_u32 s58, s58, 73728
    s_add_u32 m0, s59, 63872
    s_nop 0
    buffer_load_dwordx4 v110, s[28:31], s58 offen lds
    s_add_u32 s58, s58, 73728
    v_exp_f32 v57, v57
    v_cvt_pk_bf16_f32 v81, v54, v55
    v_exp_f32 v58, v58
    v_exp_f32 v59, v59
    v_cvt_pk_bf16_f32 v82, v56, v57
    s_nop 0
    v_cvt_pk_bf16_f32 v83, v58, v59
    s_waitcnt lgkmcnt(4)
    v_mfma_f32_32x32x16_bf16 v[44:59], v[16:19], v[8:11], 0
    v_exp_f32 v60, v60
    v_exp_f32 v61, v61
    v_exp_f32 v62, v62
    v_exp_f32 v63, v63
    v_cvt_pk_bf16_f32 v84, v60, v61
    v_exp_f32 v64, v64
    v_mfma_f32_32x32x8_bf16 v[44:59], v[20:21], v[12:13], v[44:59]
    ds_read_b64 v[22:23], v4 offset:1280
    ds_read_b64 v[24:25], v4 offset:4384
    ds_read_b64 v[26:27], v3 offset:1280
    s_cmp_lg_u32 s27, 6
    s_cbranch_scc1 sa_k5
    v_mov_b32 v6, 0xff7f
    v_cndmask_b32 v12, v12, v6, s[42:43]
sa_k5:
    v_exp_f32 v65, v65
    v_cvt_pk_bf16_f32 v85, v62, v63
    v_exp_f32 v66, v66
    v_exp_f32 v67, v67
    v_cvt_pk_bf16_f32 v86, v64, v65
    v_exp_f32 v68, v68
    v_mfma_f32_32x32x16_bf16 v[92:107], v[28:31], v[76:79], 0
    v_exp_f32 v69, v69
    v_cvt_pk_bf16_f32 v87, v66, v67
    v_exp_f32 v70, v70
    v_exp_f32 v71, v71
    v_cvt_pk_bf16_f32 v88, v68, v69
    v_exp_f32 v72, v72
    v_mfma_f32_32x32x16_bf16 v[92:107], v[32:35], v[80:83], v[92:107]
    ds_read_b64_tr_b16 v[28:29], v5 offset:1536
    ds_read_b64_tr_b16 v[30:31], v5 offset:1600
    ds_read_b64_tr_b16 v[32:33], v5 offset:1664
    ds_read_b64_tr_b16 v[34:35], v5 offset:1728
    s_add_u32 m0, s59, 72064
    s_nop 0
    buffer_load_dwordx4 v110, s[28:31], s58 offen lds
    s_add_u32 s58, s58, 73728
    s_add_u32 m0, s59, 80256
    s_nop 0
    buffer_load_dwordx4 v110, s[28:31], s58 offen lds
    s_add_u32 s58, s58, 73728
    v_exp_f32 v73, v73
    v_cvt_pk_bf16_f32 v89, v70, v71
    v_exp_f32 v74, v74
    v_exp_f32 v75, v75
    v_cvt_pk_bf16_f32 v90, v72, v73
    s_nop 0
    v_cvt_pk_bf16_f32 v91, v74, v75
    s_waitcnt lgkmcnt(4)
    v_mfma_f32_32x32x16_bf16 v[60:75], v[22:25], v[8:11], 0
    v_exp_f32 v44, v44
    v_exp_f32 v45, v45
    v_exp_f32 v46, v46
    v_exp_f32 v47, v47
    v_cvt_pk_bf16_f32 v76, v44, v45
    v_exp_f32 v48, v48
    v_mfma_f32_32x32x8_bf16 v[60:75], v[26:27], v[12:13], v[60:75]
    ds_read_b64 v[16:17], v4 offset:1024
    ds_read_b64 v[18:19], v4 offset:4128
    ds_read_b64 v[20:21], v3 offset:1024
    s_cmp_lg_u32 s27, 5
    s_cbranch_scc1 sa_k4
    v_mov_b32 v6, 0xff7f
    v_cndmask_b32 v12, v12, v6, s[42:43]
sa_k4:
    v_exp_f32 v49, v49
    v_cvt_pk_bf16_f32 v77, v46, v47
    v_exp_f32 v50, v50
    v_exp_f32 v51, v51
    v_cvt_pk_bf16_f32 v78, v48, v49
    v_exp_f32 v52, v52
    v_mfma_f32_32x32x16_bf16 v[92:107], v[36:39], v[84:87], v[92:107]
    v_exp_f32 v53, v53
    v_cvt_pk_bf16_f32 v79, v50, v51
    v_exp_f32 v54, v54
    v_exp_f32 v55, v55
    v_cvt_pk_bf16_f32 v80, v52, v53
    v_exp_f32 v56, v56
    v_mfma_f32_32x32x16_bf16 v[92:107], v[40:43], v[88:91], v[92:107]
    ds_read_b64_tr_b16 v[36:37], v5 offset:1280
    ds_read_b64_tr_b16 v[38:39], v5 offset:1344
    ds_read_b64_tr_b16 v[40:41], v5 offset:1408
    ds_read_b64_tr_b16 v[42:43], v5 offset:1472
    s_add_u32 m0, s59, 88448
    s_nop 0
    buffer_load_dwordx4 v110, s[28:31], s58 offen lds
    s_add_u32 s58, s58, 73728
    s_add_u32 m0, s59, 96640
    s_nop 0
    buffer_load_dwordx4 v110, s[28:31], s58 offen lds
    s_add_u32 s58, s58, 73728
    v_exp_f32 v57, v57
    v_cvt_pk_bf16_f32 v81, v54, v55
    v_exp_f32 v58, v58
    v_exp_f32 v59, v59
    v_cvt_pk_bf16_f32 v82, v56, v57
    s_nop 0
    v_cvt_pk_bf16_f32 v83, v58, v59
    s_waitcnt lgkmcnt(4)
    v_mfma_f32_32x32x16_bf16 v[44:59], v[16:19], v[8:11], 0
    v_exp_f32 v60, v60
    v_exp_f32 v61, v61
    v_exp_f32 v62, v62
    v_exp_f32 v63, v63
    v_cvt_pk_bf16_f32 v84, v60, v61
    v_exp_f32 v64, v64
    v_mfma_f32_32x32x8_bf16 v[44:59], v[20:21], v[12:13], v[44:59]
    ds_read_b64 v[22:23], v4 offset:768
    ds_read_b64 v[24:25], v4 offset:3872
    ds_read_b64 v[26:27], v3 offset:768
    s_cmp_lg_u32 s27, 4
    s_cbranch_scc1 sa_k3
    v_mov_b32 v6, 0xff7f
    v_cndmask_b32 v12, v12, v6, s[42:43]
sa_k3:
    v_exp_f32 v65, v65
    v_cvt_pk_bf16_f32 v85, v62, v63
    v_exp_f32 v66, v66
    v_exp_f32 v67, v67
    v_cvt_pk_bf16_f32 v86, v64, v65
    v_exp_f32 v68, v68
    v_mfma_f32_32x32x16_bf16 v[92:107], v[28:31], v[76:79], v[92:107]
    v_exp_f32 v69, v69
    v_cvt_pk_bf16_f32 v87, v66, v67
    v_exp_f32 v70, v70
    v_exp_f32 v71, v71
    v_cvt_pk_bf16_f32 v88, v68, v69
    v_exp_f32 v72, v72
    v_mfma_f32_32x32x16_bf16 v[92:107], v[32:35], v[80:83], v[92:107]
    ds_read_b64_tr_b16 v[28:29], v5 offset:1024
    ds_read_b64_tr_b16 v[30:31], v5 offset:1088
    ds_read_b64_tr_b16 v[32:33], v5 offset:1152
    ds_read_b64_tr_b16 v[34:35], v5 offset:1216
    s_add_u32 m0, s59, 104832
    s_nop 0
    buffer_load_dwordx4 v110, s[28:31], s58 offen lds
    s_add_u32 s58, s58, 73728
    s_add_u32 m0, s59, 113024
    s_nop 0
    buffer_load_dwordx4 v110, s[28:31], s58 offen lds
    s_add_u32 s58, s58, 73728
    v_exp_f32 v73, v73
    v_cvt_pk_bf16_f32 v89, v70, v71
    v_exp_f32 v74, v74
    v_exp_f32 v75, v75
    v_cvt_pk_bf16_f32 v90, v72, v73
    s_nop 0
    v_cvt_pk_bf16_f32 v91, v74, v75
    s_waitcnt lgkmcnt(4)
    v_mfma_f32_32x32x16_bf16 v[60:75], v[22:25], v[8:11], 0
    v_exp_f32 v44, v44
    v_exp_f32 v45, v45
    v_exp_f32 v46, v46
    v_exp_f32 v47, v47
    v_cvt_pk_bf16_f32 v76, v44, v45
    v_exp_f32 v48, v48
    v_mfma_f32_32x32x8_bf16 v[60:75], v[26:27], v[12:13], v[60:75]
    ds_read_b64 v[16:17], v4 offset:512
    ds_read_b64 v[18:19], v4 offset:3616
    ds_read_b64 v[20:21], v3 offset:512
    s_cmp_lg_u32 s27, 3
    s_cbranch_scc1 sa_k2
    v_mov_b32 v6, 0xff7f
    v_cndmask_b32 v12, v12, v6, s[42:43]
sa_k2:
    v_exp_f32 v49, v49
    v_cvt_pk_bf16_f32 v77, v46, v47
    v_exp_f32 v50, v50
    v_exp_f32 v51, v51
    v_cvt_pk_bf16_f32 v78, v48, v49
    v_exp_f32 v52, v52
    v_mfma_f32_32x32x16_bf16 v[92:107], v[36:39], v[84:87], v[92:107]
    v_exp_f32 v53, v53
    v_cvt_pk_bf16_f32 v79, v50, v51
    v_exp_f32 v54, v54
    v_exp_f32 v55, v55
    v_cvt_pk_bf16_f32 v80, v52, v53
    v_exp_f32 v56, v56
    v_mfma_f32_32x32x16_bf16 v[92:107], v[40:43], v[88:91], v[92:107]
    ds_read_b64_tr_b16 v[36:37], v5 offset:768
    ds_read_b64_tr_b16 v[38:39], v5 offset:832
    ds_read_b64_tr_b16 v[40:41], v5 offset:896
    ds_read_b64_tr_b16 v[42:43], v5 offset:960
    s_add_u32 m0, s59, 121216
    s_nop 0
    buffer_load_dwordx4 v110, s[28:31], s58 offen lds
    s_add_u32 s58, s58, 73728
    v_exp_f32 v57, v57
    v_cvt_pk_bf16_f32 v81, v54, v55
    v_exp_f32 v58, v58
    v_exp_f32 v59, v59
    v_cvt_pk_bf16_f32 v82, v56, v57
    s_nop 0
    v_cvt_pk_bf16_f32 v83, v58, v59
    s_waitcnt lgkmcnt(4)
    v_mfma_f32_32x32x16_bf16 v[44:59], v[16:19], v[8:11], 0
    v_exp_f32 v60, v60
    v_exp_f32 v61, v61
    v_exp_f32 v62, v62
    v_exp_f32 v63, v63
    v_cvt_pk_bf16_f32 v84, v60, v61
    v_exp_f32 v64, v64
    v_mfma_f32_32x32x8_bf16 v[44:59], v[20:21], v[12:13], v[44:59]
    ds_read_b64 v[22:23], v4 offset:256
    ds_read_b64 v[24:25], v4 offset:3360
    ds_read_b64 v[26:27], v3 offset:256
    s_cmp_lg_u32 s27, 2
    s_cbranch_scc1 sa_k1
    v_mov_b32 v6, 0xff7f
    v_cndmask_b32 v12, v12, v6, s[42:43]
sa_k1:
    v_exp_f32 v65, v65
    v_cvt_pk_bf16_f32 v85, v62, v63
    v_exp_f32 v66, v66
    v_exp_f32 v67, v67
    v_cvt_pk_bf16_f32 v86, v64, v65
    v_exp_f32 v68, v68
    v_mfma_f32_32x32x16_bf16 v[92:107], v[28:31], v[76:79], v[92:107]
    v_exp_f32 v69, v69
    v_cvt_pk_bf16_f32 v87, v66, v67
    v_exp_f32 v70, v70
    v_exp_f32 v71, v71
    v_cvt_pk_bf16_f32 v88, v68, v69
    v_exp_f32 v72, v72
    v_mfma_f32_32x32x16_bf16 v[92:107], v[32:35], v[80:83], v[92:107]
    ds_read_b64_tr_b16 v[28:29], v5 offset:512
    ds_read_b64_tr_b16 v[30:31], v5 offset:576
    ds_read_b64_tr_b16 v[32:33], v5 offset:640
    ds_read_b64_tr_b16 v[34:35], v5 offset:704
    v_exp_f32 v73, v73
    v_cvt_pk_bf16_f32 v89, v70, v71
    v_exp_f32 v74, v74
    v_exp_f32 v75, v75
    v_cvt_pk_bf16_f32 v90, v72, v73
    s_nop 0
    v_cvt_pk_bf16_f32 v91, v74, v75
    s_waitcnt lgkmcnt(4)
    v_mfma_f32_32x32x16_bf16 v[60:75], v[22:25], v[8:11], 0
    v_exp_f32 v44, v44
    v_exp_f32 v45, v45
    v_exp_f32 v46, v46
    v_exp_f32 v47, v47
    v_cvt_pk_bf16_f32 v76, v44, v45
    v_exp_f32 v48, v48
    v_mfma_f32_32x32x8_bf16 v[60:75], v[26:27], v[12:13], v[60:75]
    ds_read_b64 v[16:17], v4 offset:0
    ds_read_b64 v[18:19], v4 offset:3104
    ds_read_b64 v[20:21], v3 offset:0
    s_cmp_lg_u32 s27, 1
    s_cbranch_scc1 sa_k0
    v_mov_b32 v6, 0xff7f
    v_cndmask_b32 v12, v12, v6, s[42:43]
sa_k0:
    v_exp_f32 v49, v49
    v_cvt_pk_bf16_f32 v77, v46, v47
    v_exp_f32 v50, v50
    v_exp_f32 v51, v51
    v_cvt_pk_bf16_f32 v78, v48, v49
    v_exp_f32 v52, v52
    v_mfma_f32_32x32x16_bf16 v[92:107], v[36:39], v[84:87], v[92:107]
    v_exp_f32 v53, v53
    v_cvt_pk_bf16_f32 v79, v50, v51
    v_exp_f32 v54, v54
    v_exp_f32 v55, v55
    v_cvt_pk_bf16_f32 v80, v52, v53
    v_exp_f32 v56, v56
    v_mfma_f32_32x32x16_bf16 v[92:107], v[40:43], v[88:91], v[92:107]
    ds_read_b64_tr_b16 v[36:37], v5 offset:256
    ds_read_b64_tr_b16 v[38:39], v5 offset:320
    ds_read_b64_tr_b16 v[40:41], v5 offset:384
    ds_read_b64_tr_b16 v[42:43], v5 offset:448
    v_exp_f32 v57, v57
    v_cvt_pk_bf16_f32 v81, v54, v55
    v_exp_f32 v58, v58
    v_exp_f32 v59, v59
    v_cvt_pk_bf16_f32 v82, v56, v57
    s_nop 0
    v_cvt_pk_bf16_f32 v83, v58, v59
    s_waitcnt lgkmcnt(4)
    v_mfma_f32_32x32x16_bf16 v[44:59], v[16:19], v[8:11], v[144:159]
    v_exp_f32 v60, v60
    v_exp_f32 v61, v61
    v_exp_f32 v62, v62
    v_exp_f32 v63, v63
    v_cvt_pk_bf16_f32 v84, v60, v61
    v_exp_f32 v64, v64
    v_mfma_f32_32x32x8_bf16 v[44:59], v[20:21], v[12:13], v[44:59]
    v_exp_f32 v65, v65
    v_cvt_pk_bf16_f32 v85, v62, v63
    v_exp_f32 v66, v66
    v_exp_f32 v67, v67
    v_cvt_pk_bf16_f32 v86, v64, v65
    v_exp_f32 v68, v68
    v_mfma_f32_32x32x16_bf16 v[92:107], v[28:31], v[76:79], v[92:107]
    v_exp_f32 v69, v69
    v_cvt_pk_bf16_f32 v87, v66, v67
    v_exp_f32 v70, v70
    v_exp_f32 v71, v71
    v_cvt_pk_bf16_f32 v88, v68, v69
    v_exp_f32 v72, v72
    v_mfma_f32_32x32x16_bf16 v[92:107], v[32:35], v[80:83], v[92:107]
    ds_read_b64_tr_b16 v[28:29], v5 offset:0
    ds_read_b64_tr_b16 v[30:31], v5 offset:64
    ds_read_b64_tr_b16 v[32:33], v5 offset:128
    ds_read_b64_tr_b16 v[34:35], v5 offset:192
    v_exp_f32 v73, v73
    v_cvt_pk_bf16_f32 v89, v70, v71
    v_exp_f32 v74, v74
    v_exp_f32 v75, v75
    v_cvt_pk_bf16_f32 v90, v72, v73
    s_nop 0
    v_cvt_pk_bf16_f32 v91, v74, v75
    s_nop 3
    v_exp_f32 v44, v44
    v_exp_f32 v45, v45
    v_exp_f32 v46, v46
    v_exp_f32 v47, v47
    v_cvt_pk_bf16_f32 v76, v44, v45
    v_exp_f32 v48, v48
    v_exp_f32 v49, v49
    v_cvt_pk_bf16_f32 v77, v46, v47
    v_exp_f32 v50, v50
    v_exp_f32 v51, v51
    v_cvt_pk_bf16_f32 v78, v48, v49
    v_exp_f32 v52, v52
    s_waitcnt lgkmcnt(4)
    v_mfma_f32_32x32x16_bf16 v[92:107], v[36:39], v[84:87], v[92:107]
    v_exp_f32 v53, v53
    v_cvt_pk_bf16_f32 v79, v50, v51
    v_exp_f32 v54, v54
    v_exp_f32 v55, v55
    v_cvt_pk_bf16_f32 v80, v52, v53
    v_exp_f32 v56, v56
    v_mfma_f32_32x32x16_bf16 v[92:107], v[40:43], v[88:91], v[92:107]
    v_exp_f32 v57, v57
    v_cvt_pk_bf16_f32 v81, v54, v55
    v_exp_f32 v58, v58
    v_exp_f32 v59, v59
    v_cvt_pk_bf16_f32 v82, v56, v57
    s_nop 0
    v_cvt_pk_bf16_f32 v83, v58, v59
    s_waitcnt lgkmcnt(0)
    s_nop 0
    v_mfma_f32_32x32x16_bf16 v[92:107], v[28:31], v[76:79], v[92:107]
    v_mfma_f32_32x32x16_bf16 v[92:107], v[32:35], v[80:83], v[92:107]
    s_nop 7
    s_nop 3
    v_mov_b32 v6, v104
    v_fma_f32 v6, v92, 0, v6
    v_fma_f32 v6, v93, 0, v6
    v_fma_f32 v6, v94, 0, v6
    v_fma_f32 v6, v95, 0, v6
    v_fma_f32 v6, v96, 0, v6
    v_fma_f32 v6, v97, 0, v6
    v_fma_f32 v6, v98, 0, v6
    v_fma_f32 v6, v99, 0, v6
    v_fma_f32 v6, v100, 0, v6
    v_fma_f32 v6, v101, 0, v6
    v_fma_f32 v6, v102, 0, v6
    v_fma_f32 v6, v103, 0, v6
    s_mov_b32 s20, 0x30800000
    s_mov_b32 s21, 0x71800000
    v_cmp_nlt_f32 vcc, s20, v6
    v_cmp_ngt_f32 s[44:45], s21, v6
    s_or_b64 vcc, vcc, s[44:45]
    s_cbranch_vccnz L_fallback
L_fin:
    v_rcp_f32 v6, v104
    s_nop 0
    v_mul_f32 v92, v92, v6
    v_mul_f32 v93, v93, v6
    v_mul_f32 v94, v94, v6
    v_mul_f32 v95, v95, v6
    v_mul_f32 v96, v96, v6
    v_mul_f32 v97, v97, v6
    v_mul_f32 v98, v98, v6
    v_mul_f32 v99, v99, v6
    v_mul_f32 v100, v100, v6
    v_mul_f32 v101, v101, v6
    v_mul_f32 v102, v102, v6
    v_mul_f32 v103, v103, v6
    v_cvt_pk_bf16_f32 v76, v92, v93
    v_cvt_pk_bf16_f32 v77, v94, v95
    v_cvt_pk_bf16_f32 v78, v96, v97
    v_cvt_pk_bf16_f32 v79, v98, v99
    v_cvt_pk_bf16_f32 v80, v100, v101
    v_cvt_pk_bf16_f32 v81, v102, v103
    v_lshrrev_b32 v6, 4, v1
    v_mul_u32_u24 v6, 18432, v6
    v_and_b32 v7, 15, v1
    v_lshl_add_u32 v6, v7, 4, v6
    v_lshl_add_u32 v7, v15, 8, v6
    s_mul_i32 s26, s46, 36864
    s_add_u32 s26, s26, 9437184
    s_lshl_b32 s19, s40, 1
    s_add_u32 s19, s19, s23
    s_lshl_b32 s20, s19, 9
    s_add_u32 s20, s20, s26
    buffer_store_dwordx4 v[76:79], v7, s[36:39], s20 offen sc1
    s_lshr_b32 s20, s19, 2
    s_lshl_b32 s20, s20, 8
    s_and_b32 s21, s19, 3
    s_lshl_b32 s21, s21, 2
    s_add_u32 s20, s20, s21
    s_add_u32 s20, s20, s26
    s_add_u32 s20, s20, 16384
    s_cmp_eq_u32 s23, 0
    s_cbranch_scc1 L_ev
    v_mov_b32 v80, v81
L_ev:
    s_mov_b32 exec_lo, 0xffffffff
    s_mov_b32 exec_hi, 0x0
    buffer_store_dword v80, v6, s[36:39], s20 offen sc1
    s_mov_b64 exec, -1
    s_load_dwordx2 s[4:5], s[0:1], 0
    s_load_dwordx2 s[8:9], s[0:1], 80
    s_mul_i32 s19, s56, 28
    s_sub_u32 s19, s2, s19
    s_mul_i32 s21, s19, 5
    s_lshl_b32 s22, s19, 2
    s_add_u32 s22, s22, 16
    s_cmp_lt_u32 s19, 16
    s_cselect_b32 s19, s21, s22
    s_cselect_b32 s43, 5, 4
    s_cmp_ge_u32 s2, 252
    s_cselect_b32 s43, 0, s43
    s_add_u32 s21, s19, s18
    s_min_u32 s21, s21, 127
    v_and_b32 v2, 15, v0
    v_lshrrev_b32 v3, 4, v0
    s_lshl_b32 s40, s21, 4
    v_add_u32 v4, s40, v2
    v_mul_u32_u24 v5, 1152, v4
    v_lshl_add_u32 v5, v3, 3, v5
    s_waitcnt lgkmcnt(0)
    s_mov_b32 s24, s4
    s_mov_b32 s25, s5
    s_mov_b32 s26, 2359296
    s_mov_b32 s27, 0x00020000
    s_mov_b32 s32, s8
    s_mov_b32 s33, s9
    s_mov_b32 s34, 2359296
    s_mov_b32 s35, 0x00020000
    s_lshl_b32 s19, s56, 6
    v_add_u32 v6, s19, v0
    v_lshrrev_b32 v7, 2, v6
    v_add_u32 v7, 224, v7
    v_subrev_u32 v8, 128, v6
    v_lshrrev_b32 v8, 1, v8
    v_cmp_gt_u32 vcc, 128, v6
    s_lshr_b32 s19, s40, 9
    s_bfe_u32 s20, s40, 0x20007
    s_lshl_b32 s20, s20, 3
    s_add_u32 s19, s19, s20
    s_add_u32 s19, s19, 196
    v_cndmask_b32 v6, v8, v7, vcc
    v_mov_b32 v7, s19
    s_mov_b32 s44, 0xaaaaaaaa
    s_mov_b32 s45, 0xaaaaaaaa
    v_cndmask_b32 v6, v6, v7, s[44:45]
    v_lshlrev_b32 v7, 7, v6
    s_mov_b32 s22, 14163984
    buffer_load_dwordx2 v[8:9], v7, s[36:39], s22 offen sc0 sc1
    v_mov_b32 v10, 22048
    v_mov_b32 v11, 1
    s_waitcnt vmcnt(0)
    s_mov_b64 exec, 1
    ds_add_rtn_u32 v11, v10, v11
    s_mov_b64 exec, -1
    s_waitcnt lgkmcnt(0)
    v_readfirstlane_b32 s22, v11
    s_cmp_lg_u32 s22, 7
    s_cbranch_scc1 L_nf4
    s_lshl_b32 s22, s2, 7
    s_add_u32 s22, s22, 14163992
    v_mov_b32 v12, s22
    v_mov_b32 v14, s88
    v_mov_b32 v15, s89
    s_mov_b64 exec, 1
    buffer_store_dwordx2 v[14:15], v12, s[36:39], 0 offen sc0 sc1
    s_mov_b64 exec, -1
L_nf4:
    s_cmp_lt_u32 s18, s43
    s_cbranch_scc1 L_g2
    s_cmp_lg_u32 s2, 255
    s_cbranch_scc1 L_end
    s_cmp_lg_u32 s18, 0
    s_cbranch_scc1 L_end
    v_add_u32 v6, 0, v0
    v_lshlrev_b32 v6, 7, v6
    s_mov_b32 s22, 14163992
    s_mov_b32 s97, 40000
fspin_52:
    buffer_load_dwordx2 v[8:9], v6, s[36:39], s22 offen sc0 sc1
    s_waitcnt vmcnt(0)
    v_cmp_ne_u64 vcc, s[88:89], v[8:9]
    s_cbranch_vccz fdone_53
    s_sleep 8
    s_sub_u32 s97, s97, 1
    s_cbranch_scc0 fspin_52
fdone_53:
    v_add_u32 v6, 64, v0
    v_lshlrev_b32 v6, 7, v6
    s_mov_b32 s22, 14163992
    s_mov_b32 s97, 40000
fspin_54:
    buffer_load_dwordx2 v[8:9], v6, s[36:39], s22 offen sc0 sc1
    s_waitcnt vmcnt(0)
    v_cmp_ne_u64 vcc, s[88:89], v[8:9]
    s_cbranch_vccz fdone_55
    s_sleep 8
    s_sub_u32 s97, s97, 1
    s_cbranch_scc0 fspin_54
fdone_55:
    v_add_u32 v6, 128, v0
    v_lshlrev_b32 v6, 7, v6
    s_mov_b32 s22, 14163992
    s_mov_b32 s97, 40000
fspin_56:
    buffer_load_dwordx2 v[8:9], v6, s[36:39], s22 offen sc0 sc1
    s_waitcnt vmcnt(0)
    v_cmp_ne_u64 vcc, s[88:89], v[8:9]
    s_cbranch_vccz fdone_57
    s_sleep 8
    s_sub_u32 s97, s97, 1
    s_cbranch_scc0 fspin_56
fdone_57:
    v_add_u32 v6, 192, v0
    v_lshlrev_b32 v6, 7, v6
    s_mov_b32 s22, 14163992
    s_mov_b32 s97, 40000
fspin_58:
    buffer_load_dwordx2 v[8:9], v6, s[36:39], s22 offen sc0 sc1
    s_waitcnt vmcnt(0)
    v_cmp_ne_u64 vcc, s[88:89], v[8:9]
    s_cbranch_vccz fdone_59
    s_sleep 8
    s_sub_u32 s97, s97, 1
    s_cbranch_scc0 fspin_58
fdone_59:
    v_mov_b32 v6, 14196736
    v_mov_b32 v8, s88
    v_mov_b32 v9, s89
    s_mov_b64 exec, 1
    buffer_store_dwordx2 v[8:9], v6, s[36:39], 0 offen sc0 sc1
    s_endpgm
L_g2:
    buffer_load_dwordx2 v[136:137], v5, s[24:27], s57 offen offset:0
    buffer_load_dwordx2 v[138:139], v5, s[24:27], s57 offen offset:32
    buffer_load_dwordx2 v[140:141], v5, s[24:27], s57 offen offset:64
    buffer_load_dwordx2 v[142:143], v5, s[24:27], s57 offen offset:96
    v_cmp_ne_u64 vcc, s[88:89], v[8:9]
    s_cbranch_vccz L_f3ok
    v_lshlrev_b32 v6, 7, v6
    s_mov_b32 s22, 14163984
    s_mov_b32 s97, 40000
fspin_60:
    buffer_load_dwordx2 v[8:9], v6, s[36:39], s22 offen sc0 sc1
    s_waitcnt vmcnt(0)
    v_cmp_ne_u64 vcc, s[88:89], v[8:9]
    s_cbranch_vccz fdone_61
    s_sleep 2
    s_sub_u32 s97, s97, 1
    s_cbranch_scc0 fspin_60
fdone_61:
L_f3ok:
    v_lshrrev_b32 v6, 1, v0
    v_lshlrev_b32 v6, 12, v6
    v_and_b32 v8, 1, v0
    v_lshl_add_u32 v6, v8, 4, v6
    s_lshl_b32 s45, s56, 18
    s_lshl_b32 s46, s21, 5
    s_add_u32 s45, s45, s46
    s_add_u32 s45, s45, 11796480
    s_lshl_b32 s44, s18, 11
    s_add_u32 m0, s44, 0
    s_nop 0
    buffer_load_dwordx4 v6, s[36:39], s45 offen sc1 lds
    s_add_u32 s45, s45, 131072
    s_add_u32 m0, s44, 1024
    s_nop 0
    buffer_load_dwordx4 v6, s[36:39], s45 offen sc1 lds
    s_add_u32 s45, s45, 131072
    v_lshlrev_b32 v6, 2, v4
    s_mov_b32 s45, 14155776
    buffer_load_dword v144, v6, s[36:39], s45 offen sc1
    v_bfe_u32 v6, v0, 2, 2
    v_and_b32 v11, 3, v0
    v_lshrrev_b32 v8, 1, v3
    v_mul_u32_u24 v8, 20, v8
    v_and_b32 v9, 1, v3
    v_lshl_add_u32 v8, v9, 2, v8
    v_add_u32 v8, v8, v6
    v_bfe_u32 v9, v8, 1, 2
    v_lshlrev_b32 v8, 7, v8
    v_lshl_add_u32 v8, v11, 3, v8
    v_add_u32 v8, 55680, v8
    v_xor_b32 v10, 0, v9
    v_lshl_add_u32 v148, v10, 5, v8
    v_xor_b32 v10, 1, v9
    v_lshl_add_u32 v149, v10, 5, v8
    v_xor_b32 v10, 2, v9
    v_lshl_add_u32 v150, v10, 5, v8
    v_xor_b32 v10, 3, v9
    v_lshl_add_u32 v151, v10, 5, v8
    v_mul_u32_u24 v8, 72, v3
    v_add3_u32 v8, v8, v6, 16
    v_bfe_u32 v9, v8, 1, 2
    v_lshlrev_b32 v8, 7, v8
    v_lshl_add_u32 v8, v11, 3, v8
    v_add_u32 v8, 55680, v8
    v_xor_b32 v10, 0, v9
    v_lshl_add_u32 v152, v10, 5, v8
    v_xor_b32 v10, 1, v9
    v_lshl_add_u32 v153, v10, 5, v8
    v_xor_b32 v10, 2, v9
    v_lshl_add_u32 v154, v10, 5, v8
    v_xor_b32 v10, 3, v9
    v_lshl_add_u32 v155, v10, 5, v8
    v_lshl_add_u32 v8, v3, 2, v6
    v_lshlrev_b32 v8, 5, v8
    v_lshl_add_u32 v8, v11, 3, v8
    v_add_u32 v8, s44, v8
    s_waitcnt vmcnt(0)
    ds_read_b64_tr_b16 v[172:173], v8 offset:0
    ds_read_b64_tr_b16 v[174:175], v8 offset:512
    ds_read_b64_tr_b16 v[176:177], v8 offset:1024
    ds_read_b64_tr_b16 v[178:179], v8 offset:1536
    v_sub_f32 v9, 1.0, v144
    v_cvt_pk_bf16_f32 v9, 0, v9
    s_mov_b32 s42, 0xffff0000
    s_waitcnt lgkmcnt(0)
    v_lshlrev_b32 v156, 16, v136
    v_lshlrev_b32 v180, 16, v172
    v_and_b32 v157, s42, v136
    v_and_b32 v181, s42, v172
    v_lshlrev_b32 v158, 16, v137
    v_lshlrev_b32 v182, 16, v173
    v_and_b32 v159, s42, v137
    v_and_b32 v183, s42, v173
    v_mul_f32 v156, v156, v180
    v_mul_f32 v157, v157, v181
    v_mul_f32 v158, v158, v182
    v_mul_f32 v159, v159, v183
    v_cvt_pk_bf16_f32 v156, 0, v156
    v_cvt_pk_bf16_f32 v157, 0, v157
    v_cvt_pk_bf16_f32 v158, 0, v158
    v_cvt_pk_bf16_f32 v159, 0, v159
    v_mul_f32 v156, v156, v9
    v_mul_f32 v157, v157, v9
    v_mul_f32 v158, v158, v9
    v_mul_f32 v159, v159, v9
    v_cvt_pk_bf16_f32 v156, 0, v156
    v_cvt_pk_bf16_f32 v157, 0, v157
    v_cvt_pk_bf16_f32 v158, 0, v158
    v_cvt_pk_bf16_f32 v159, 0, v159
    v_lshlrev_b32 v160, 16, v138
    v_lshlrev_b32 v180, 16, v174
    v_and_b32 v161, s42, v138
    v_and_b32 v181, s42, v174
    v_lshlrev_b32 v162, 16, v139
    v_lshlrev_b32 v182, 16, v175
    v_and_b32 v163, s42, v139
    v_and_b32 v183, s42, v175
    v_mul_f32 v160, v160, v180
    v_mul_f32 v161, v161, v181
    v_mul_f32 v162, v162, v182
    v_mul_f32 v163, v163, v183
    v_cvt_pk_bf16_f32 v160, 0, v160
    v_cvt_pk_bf16_f32 v161, 0, v161
    v_cvt_pk_bf16_f32 v162, 0, v162
    v_cvt_pk_bf16_f32 v163, 0, v163
    v_mul_f32 v160, v160, v9
    v_mul_f32 v161, v161, v9
    v_mul_f32 v162, v162, v9
    v_mul_f32 v163, v163, v9
    v_cvt_pk_bf16_f32 v160, 0, v160
    v_cvt_pk_bf16_f32 v161, 0, v161
    v_cvt_pk_bf16_f32 v162, 0, v162
    v_cvt_pk_bf16_f32 v163, 0, v163
    v_lshlrev_b32 v164, 16, v140
    v_lshlrev_b32 v180, 16, v176
    v_and_b32 v165, s42, v140
    v_and_b32 v181, s42, v176
    v_lshlrev_b32 v166, 16, v141
    v_lshlrev_b32 v182, 16, v177
    v_and_b32 v167, s42, v141
    v_and_b32 v183, s42, v177
    v_mul_f32 v164, v164, v180
    v_mul_f32 v165, v165, v181
    v_mul_f32 v166, v166, v182
    v_mul_f32 v167, v167, v183
    v_cvt_pk_bf16_f32 v164, 0, v164
    v_cvt_pk_bf16_f32 v165, 0, v165
    v_cvt_pk_bf16_f32 v166, 0, v166
    v_cvt_pk_bf16_f32 v167, 0, v167
    v_mul_f32 v164, v164, v9
    v_mul_f32 v165, v165, v9
    v_mul_f32 v166, v166, v9
    v_mul_f32 v167, v167, v9
    v_cvt_pk_bf16_f32 v164, 0, v164
    v_cvt_pk_bf16_f32 v165, 0, v165
    v_cvt_pk_bf16_f32 v166, 0, v166
    v_cvt_pk_bf16_f32 v167, 0, v167
    v_lshlrev_b32 v168, 16, v142
    v_lshlrev_b32 v180, 16, v178
    v_and_b32 v169, s42, v142
    v_and_b32 v181, s42, v178
    v_lshlrev_b32 v170, 16, v143
    v_lshlrev_b32 v182, 16, v179
    v_and_b32 v171, s42, v143
    v_and_b32 v183, s42, v179
    v_mul_f32 v168, v168, v180
    v_mul_f32 v169, v169, v181
    v_mul_f32 v170, v170, v182
    v_mul_f32 v171, v171, v183
    v_cvt_pk_bf16_f32 v168, 0, v168
    v_cvt_pk_bf16_f32 v169, 0, v169
    v_cvt_pk_bf16_f32 v170, 0, v170
    v_cvt_pk_bf16_f32 v171, 0, v171
    v_mul_f32 v168, v168, v9
    v_mul_f32 v169, v169, v9
    v_mul_f32 v170, v170, v9
    v_mul_f32 v171, v171, v9
    v_cvt_pk_bf16_f32 v168, 0, v168
    v_cvt_pk_bf16_f32 v169, 0, v169
    v_cvt_pk_bf16_f32 v170, 0, v170
    v_cvt_pk_bf16_f32 v171, 0, v171
    v_mov_b32 v10, 22048
    s_mov_b32 s97, 320000
gb_62:
    ds_read_b32 v11, v10
    s_sub_u32 s97, s97, 1
    s_cbranch_scc1 gbd_63
    s_waitcnt lgkmcnt(0)
    v_readfirstlane_b32 s22, v11
    s_cmp_ge_u32 s22, 8
    s_cbranch_scc1 gbd_63
    s_sleep 1
    s_branch gb_62
gbd_63:
    s_waitcnt lgkmcnt(0)
    ds_read_b64_tr_b16 v[104:105], v148 offset:0
    ds_read_b64_tr_b16 v[106:107], v148 offset:1024
    ds_read_b64_tr_b16 v[108:109], v149 offset:0
    ds_read_b64_tr_b16 v[110:111], v149 offset:1024
    ds_read_b64_tr_b16 v[112:113], v150 offset:0
    ds_read_b64_tr_b16 v[114:115], v150 offset:1024
    ds_read_b64_tr_b16 v[116:117], v151 offset:0
    ds_read_b64_tr_b16 v[118:119], v151 offset:1024
    s_lshr_b32 s19, s21, 3
    s_lshl_b32 s19, s19, 4
    v_add_u32 v6, s19, v2
    s_add_u32 s19, s21, s43
    s_sub_u32 s19, s19, 1
    s_lshr_b32 s19, s19, 3
    s_lshl_b32 s19, s19, 4
    v_add_u32 v7, s19, v2
    s_mov_b32 s46, 0
    s_mov_b32 s47, -1
    v_cndmask_b32 v6, v6, v7, s[46:47]
    s_cmp_lg_u32 s18, 0
    s_cbranch_scc1 L_w4_o
    v_lshlrev_b32 v6, 7, v6
    s_mov_b32 s22, 14163992
    s_mov_b32 s97, 40000
fspin_64:
    buffer_load_dwordx2 v[10:11], v6, s[36:39], s22 offen sc0 sc1
    s_waitcnt vmcnt(0)
    v_cmp_ne_u64 vcc, s[88:89], v[10:11]
    s_cbranch_vccz fdone_65
    s_sleep 2
    s_sub_u32 s97, s97, 1
    s_cbranch_scc0 fspin_64
fdone_65:
    v_mov_b32 v10, 22056
    v_mov_b32 v11, 1
    ds_write_b32 v10, v11
    s_branch L_w4_j
L_w4_o:
    v_mov_b32 v10, 22056
    s_mov_b32 s97, 320000
gb_66:
    ds_read_b32 v11, v10
    s_sub_u32 s97, s97, 1
    s_cbranch_scc1 gbd_67
    s_waitcnt lgkmcnt(0)
    v_readfirstlane_b32 s22, v11
    s_cmp_ge_u32 s22, 1
    s_cbranch_scc1 gbd_67
    s_sleep 1
    s_branch gb_66
gbd_67:
    s_waitcnt lgkmcnt(0)
L_w4_j:
    v_lshlrev_b32 v7, 4, v0
    s_mul_i32 s22, s21, 18432
    s_add_u32 s22, s22, 9437184
    buffer_load_dwordx4 v[16:19], v7, s[36:39], s22 offen offset:0 sc1
    buffer_load_dwordx4 v[20:23], v7, s[36:39], s22 offen offset:1024 sc1
    buffer_load_dwordx4 v[24:27], v7, s[36:39], s22 offen offset:2048 sc1
    buffer_load_dwordx4 v[28:31], v7, s[36:39], s22 offen offset:3072 sc1
    s_add_u32 s22, s22, 4096
    buffer_load_dwordx4 v[32:35], v7, s[36:39], s22 offen offset:0 sc1
    buffer_load_dwordx4 v[36:39], v7, s[36:39], s22 offen offset:1024 sc1
    buffer_load_dwordx4 v[40:43], v7, s[36:39], s22 offen offset:2048 sc1
    buffer_load_dwordx4 v[44:47], v7, s[36:39], s22 offen offset:3072 sc1
    s_add_u32 s22, s22, 4096
    buffer_load_dwordx4 v[48:51], v7, s[36:39], s22 offen offset:0 sc1
    buffer_load_dwordx4 v[52:55], v7, s[36:39], s22 offen offset:1024 sc1
    buffer_load_dwordx4 v[56:59], v7, s[36:39], s22 offen offset:2048 sc1
    buffer_load_dwordx4 v[60:63], v7, s[36:39], s22 offen offset:3072 sc1
    s_add_u32 s22, s22, 4096
    buffer_load_dwordx4 v[64:67], v7, s[36:39], s22 offen offset:0 sc1
    buffer_load_dwordx4 v[68:71], v7, s[36:39], s22 offen offset:1024 sc1
    buffer_load_dwordx4 v[72:75], v7, s[36:39], s22 offen offset:2048 sc1
    buffer_load_dwordx4 v[76:79], v7, s[36:39], s22 offen offset:3072 sc1
    s_add_u32 s22, s22, 4096
    buffer_load_dwordx4 v[80:83], v7, s[36:39], s22 offen offset:0 sc1
    buffer_load_dwordx4 v[84:87], v7, s[36:39], s22 offen offset:1024 sc1
    ds_read_b64_tr_b16 v[120:121], v150 offset:4608
    ds_read_b64_tr_b16 v[122:123], v150 offset:5632
    ds_read_b64_tr_b16 v[124:125], v151 offset:4608
    ds_read_b64_tr_b16 v[126:127], v151 offset:5632
    ds_read_b64_tr_b16 v[128:129], v148 offset:4608
    ds_read_b64_tr_b16 v[130:131], v148 offset:5632
    ds_read_b64_tr_b16 v[132:133], v149 offset:4608
    ds_read_b64_tr_b16 v[134:135], v149 offset:5632
    s_waitcnt vmcnt(17)
    s_waitcnt lgkmcnt(9)
    v_mfma_f32_16x16x32_bf16 v[88:91], v[104:107], v[16:19], 0
    v_mfma_f32_16x16x32_bf16 v[92:95], v[108:111], v[16:19], 0
    v_mfma_f32_16x16x32_bf16 v[96:99], v[112:115], v[16:19], 0
    v_mfma_f32_16x16x32_bf16 v[100:103], v[116:119], v[16:19], 0
    ds_read_b64_tr_b16 v[104:105], v148 offset:9216
    ds_read_b64_tr_b16 v[106:107], v148 offset:10240
    ds_read_b64_tr_b16 v[108:109], v149 offset:9216
    ds_read_b64_tr_b16 v[110:111], v149 offset:10240
    ds_read_b64_tr_b16 v[112:113], v150 offset:9216
    ds_read_b64_tr_b16 v[114:115], v150 offset:10240
    ds_read_b64_tr_b16 v[116:117], v151 offset:9216
    ds_read_b64_tr_b16 v[118:119], v151 offset:10240
    s_waitcnt vmcnt(16)
    s_waitcnt lgkmcnt(8)
    v_mfma_f32_16x16x32_bf16 v[88:91], v[120:123], v[20:23], v[88:91]
    v_mfma_f32_16x16x32_bf16 v[92:95], v[124:127], v[20:23], v[92:95]
    v_mfma_f32_16x16x32_bf16 v[96:99], v[128:131], v[20:23], v[96:99]
    v_mfma_f32_16x16x32_bf16 v[100:103], v[132:135], v[20:23], v[100:103]
    ds_read_b64_tr_b16 v[120:121], v150 offset:13824
    ds_read_b64_tr_b16 v[122:123], v150 offset:14848
    ds_read_b64_tr_b16 v[124:125], v151 offset:13824
    ds_read_b64_tr_b16 v[126:127], v151 offset:14848
    ds_read_b64_tr_b16 v[128:129], v148 offset:13824
    ds_read_b64_tr_b16 v[130:131], v148 offset:14848
    ds_read_b64_tr_b16 v[132:133], v149 offset:13824
    ds_read_b64_tr_b16 v[134:135], v149 offset:14848
    s_waitcnt vmcnt(15)
    s_waitcnt lgkmcnt(8)
    v_mfma_f32_16x16x32_bf16 v[88:91], v[104:107], v[24:27], v[88:91]
    v_mfma_f32_16x16x32_bf16 v[92:95], v[108:111], v[24:27], v[92:95]
    v_mfma_f32_16x16x32_bf16 v[96:99], v[112:115], v[24:27], v[96:99]
    v_mfma_f32_16x16x32_bf16 v[100:103], v[116:119], v[24:27], v[100:103]
    ds_read_b64_tr_b16 v[104:105], v148 offset:18432
    ds_read_b64_tr_b16 v[106:107], v148 offset:19456
    ds_read_b64_tr_b16 v[108:109], v149 offset:18432
    ds_read_b64_tr_b16 v[110:111], v149 offset:19456
    ds_read_b64_tr_b16 v[112:113], v150 offset:18432
    ds_read_b64_tr_b16 v[114:115], v150 offset:19456
    ds_read_b64_tr_b16 v[116:117], v151 offset:18432
    ds_read_b64_tr_b16 v[118:119], v151 offset:19456
    s_waitcnt vmcnt(14)
    s_waitcnt lgkmcnt(8)
    v_mfma_f32_16x16x32_bf16 v[88:91], v[120:123], v[28:31], v[88:91]
    v_mfma_f32_16x16x32_bf16 v[92:95], v[124:127], v[28:31], v[92:95]
    v_mfma_f32_16x16x32_bf16 v[96:99], v[128:131], v[28:31], v[96:99]
    v_mfma_f32_16x16x32_bf16 v[100:103], v[132:135], v[28:31], v[100:103]
    ds_read_b64_tr_b16 v[120:121], v150 offset:23040
    ds_read_b64_tr_b16 v[122:123], v150 offset:24064
    ds_read_b64_tr_b16 v[124:125], v151 offset:23040
    ds_read_b64_tr_b16 v[126:127], v151 offset:24064
    ds_read_b64_tr_b16 v[128:129], v148 offset:23040
    ds_read_b64_tr_b16 v[130:131], v148 offset:24064
    ds_read_b64_tr_b16 v[132:133], v149 offset:23040
    ds_read_b64_tr_b16 v[134:135], v149 offset:24064
    s_waitcnt vmcnt(13)
    s_waitcnt lgkmcnt(8)
    v_mfma_f32_16x16x32_bf16 v[88:91], v[104:107], v[32:35], v[88:91]
    v_mfma_f32_16x16x32_bf16 v[92:95], v[108:111], v[32:35], v[92:95]
    v_mfma_f32_16x16x32_bf16 v[96:99], v[112:115], v[32:35], v[96:99]
    v_mfma_f32_16x16x32_bf16 v[100:103], v[116:119], v[32:35], v[100:103]
    ds_read_b64_tr_b16 v[104:105], v148 offset:27648
    ds_read_b64_tr_b16 v[106:107], v148 offset:28672
    ds_read_b64_tr_b16 v[108:109], v149 offset:27648
    ds_read_b64_tr_b16 v[110:111], v149 offset:28672
    ds_read_b64_tr_b16 v[112:113], v150 offset:27648
    ds_read_b64_tr_b16 v[114:115], v150 offset:28672
    ds_read_b64_tr_b16 v[116:117], v151 offset:27648
    ds_read_b64_tr_b16 v[118:119], v151 offset:28672
    s_waitcnt vmcnt(12)
    s_waitcnt lgkmcnt(8)
    v_mfma_f32_16x16x32_bf16 v[88:91], v[120:123], v[36:39], v[88:91]
    v_mfma_f32_16x16x32_bf16 v[92:95], v[124:127], v[36:39], v[92:95]
    v_mfma_f32_16x16x32_bf16 v[96:99], v[128:131], v[36:39], v[96:99]
    v_mfma_f32_16x16x32_bf16 v[100:103], v[132:135], v[36:39], v[100:103]
    ds_read_b64_tr_b16 v[120:121], v150 offset:32256
    ds_read_b64_tr_b16 v[122:123], v150 offset:33280
    ds_read_b64_tr_b16 v[124:125], v151 offset:32256
    ds_read_b64_tr_b16 v[126:127], v151 offset:33280
    ds_read_b64_tr_b16 v[128:129], v148 offset:32256
    ds_read_b64_tr_b16 v[130:131], v148 offset:33280
    ds_read_b64_tr_b16 v[132:133], v149 offset:32256
    ds_read_b64_tr_b16 v[134:135], v149 offset:33280
    s_waitcnt vmcnt(11)
    s_waitcnt lgkmcnt(8)
    v_mfma_f32_16x16x32_bf16 v[88:91], v[104:107], v[40:43], v[88:91]
    v_mfma_f32_16x16x32_bf16 v[92:95], v[108:111], v[40:43], v[92:95]
    v_mfma_f32_16x16x32_bf16 v[96:99], v[112:115], v[40:43], v[96:99]
    v_mfma_f32_16x16x32_bf16 v[100:103], v[116:119], v[40:43], v[100:103]
    ds_read_b64_tr_b16 v[104:105], v148 offset:36864
    ds_read_b64_tr_b16 v[106:107], v148 offset:37888
    ds_read_b64_tr_b16 v[108:109], v149 offset:36864
    ds_read_b64_tr_b16 v[110:111], v149 offset:37888
    ds_read_b64_tr_b16 v[112:113], v150 offset:36864
    ds_read_b64_tr_b16 v[114:115], v150 offset:37888
    ds_read_b64_tr_b16 v[116:117], v151 offset:36864
    ds_read_b64_tr_b16 v[118:119], v151 offset:37888
    s_waitcnt vmcnt(10)
    s_waitcnt lgkmcnt(8)
    v_mfma_f32_16x16x32_bf16 v[88:91], v[120:123], v[44:47], v[88:91]
    v_mfma_f32_16x16x32_bf16 v[92:95], v[124:127], v[44:47], v[92:95]
    v_mfma_f32_16x16x32_bf16 v[96:99], v[128:131], v[44:47], v[96:99]
    v_mfma_f32_16x16x32_bf16 v[100:103], v[132:135], v[44:47], v[100:103]
    ds_read_b64_tr_b16 v[120:121], v150 offset:41472
    ds_read_b64_tr_b16 v[122:123], v150 offset:42496
    ds_read_b64_tr_b16 v[124:125], v151 offset:41472
    ds_read_b64_tr_b16 v[126:127], v151 offset:42496
    ds_read_b64_tr_b16 v[128:129], v148 offset:41472
    ds_read_b64_tr_b16 v[130:131], v148 offset:42496
    ds_read_b64_tr_b16 v[132:133], v149 offset:41472
    ds_read_b64_tr_b16 v[134:135], v149 offset:42496
    s_waitcnt vmcnt(9)
    s_waitcnt lgkmcnt(8)
    v_mfma_f32_16x16x32_bf16 v[88:91], v[104:107], v[48:51], v[88:91]
    v_mfma_f32_16x16x32_bf16 v[92:95], v[108:111], v[48:51], v[92:95]
    v_mfma_f32_16x16x32_bf16 v[96:99], v[112:115], v[48:51], v[96:99]
    v_mfma_f32_16x16x32_bf16 v[100:103], v[116:119], v[48:51], v[100:103]
    ds_read_b64_tr_b16 v[104:105], v148 offset:46080
    ds_read_b64_tr_b16 v[106:107], v148 offset:47104
    ds_read_b64_tr_b16 v[108:109], v149 offset:46080
    ds_read_b64_tr_b16 v[110:111], v149 offset:47104
    ds_read_b64_tr_b16 v[112:113], v150 offset:46080
    ds_read_b64_tr_b16 v[114:115], v150 offset:47104
    ds_read_b64_tr_b16 v[116:117], v151 offset:46080
    ds_read_b64_tr_b16 v[118:119], v151 offset:47104
    s_waitcnt vmcnt(8)
    s_waitcnt lgkmcnt(8)
    v_mfma_f32_16x16x32_bf16 v[88:91], v[120:123], v[52:55], v[88:91]
    v_mfma_f32_16x16x32_bf16 v[92:95], v[124:127], v[52:55], v[92:95]
    v_mfma_f32_16x16x32_bf16 v[96:99], v[128:131], v[52:55], v[96:99]
    v_mfma_f32_16x16x32_bf16 v[100:103], v[132:135], v[52:55], v[100:103]
    ds_read_b64_tr_b16 v[120:121], v150 offset:50688
    ds_read_b64_tr_b16 v[122:123], v150 offset:51712
    ds_read_b64_tr_b16 v[124:125], v151 offset:50688
    ds_read_b64_tr_b16 v[126:127], v151 offset:51712
    ds_read_b64_tr_b16 v[128:129], v148 offset:50688
    ds_read_b64_tr_b16 v[130:131], v148 offset:51712
    ds_read_b64_tr_b16 v[132:133], v149 offset:50688
    ds_read_b64_tr_b16 v[134:135], v149 offset:51712
    s_waitcnt vmcnt(7)
    s_waitcnt lgkmcnt(8)
    v_mfma_f32_16x16x32_bf16 v[88:91], v[104:107], v[56:59], v[88:91]
    v_mfma_f32_16x16x32_bf16 v[92:95], v[108:111], v[56:59], v[92:95]
    v_mfma_f32_16x16x32_bf16 v[96:99], v[112:115], v[56:59], v[96:99]
    v_mfma_f32_16x16x32_bf16 v[100:103], v[116:119], v[56:59], v[100:103]
    v_add_u32 v148, 55296, v148
    v_add_u32 v149, 55296, v149
    v_add_u32 v150, 55296, v150
    v_add_u32 v151, 55296, v151
    ds_read_b64_tr_b16 v[104:105], v148 offset:0
    ds_read_b64_tr_b16 v[106:107], v148 offset:1024
    ds_read_b64_tr_b16 v[108:109], v149 offset:0
    ds_read_b64_tr_b16 v[110:111], v149 offset:1024
    ds_read_b64_tr_b16 v[112:113], v150 offset:0
    ds_read_b64_tr_b16 v[114:115], v150 offset:1024
    ds_read_b64_tr_b16 v[116:117], v151 offset:0
    ds_read_b64_tr_b16 v[118:119], v151 offset:1024
    s_waitcnt vmcnt(6)
    s_waitcnt lgkmcnt(8)
    v_mfma_f32_16x16x32_bf16 v[88:91], v[120:123], v[60:63], v[88:91]
    v_mfma_f32_16x16x32_bf16 v[92:95], v[124:127], v[60:63], v[92:95]
    v_mfma_f32_16x16x32_bf16 v[96:99], v[128:131], v[60:63], v[96:99]
    v_mfma_f32_16x16x32_bf16 v[100:103], v[132:135], v[60:63], v[100:103]
    ds_read_b64_tr_b16 v[120:121], v150 offset:4608
    ds_read_b64_tr_b16 v[122:123], v150 offset:5632
    ds_read_b64_tr_b16 v[124:125], v151 offset:4608
    ds_read_b64_tr_b16 v[126:127], v151 offset:5632
    ds_read_b64_tr_b16 v[128:129], v148 offset:4608
    ds_read_b64_tr_b16 v[130:131], v148 offset:5632
    ds_read_b64_tr_b16 v[132:133], v149 offset:4608
    ds_read_b64_tr_b16 v[134:135], v149 offset:5632
    s_waitcnt vmcnt(5)
    s_waitcnt lgkmcnt(8)
    v_mfma_f32_16x16x32_bf16 v[88:91], v[104:107], v[64:67], v[88:91]
    v_mfma_f32_16x16x32_bf16 v[92:95], v[108:111], v[64:67], v[92:95]
    v_mfma_f32_16x16x32_bf16 v[96:99], v[112:115], v[64:67], v[96:99]
    v_mfma_f32_16x16x32_bf16 v[100:103], v[116:119], v[64:67], v[100:103]
    ds_read_b64_tr_b16 v[104:105], v148 offset:9216
    ds_read_b64_tr_b16 v[106:107], v148 offset:10240
    ds_read_b64_tr_b16 v[108:109], v149 offset:9216
    ds_read_b64_tr_b16 v[110:111], v149 offset:10240
    ds_read_b64_tr_b16 v[112:113], v150 offset:9216
    ds_read_b64_tr_b16 v[114:115], v150 offset:10240
    ds_read_b64_tr_b16 v[116:117], v151 offset:9216
    ds_read_b64_tr_b16 v[118:119], v151 offset:10240
    s_waitcnt vmcnt(4)
    s_waitcnt lgkmcnt(8)
    v_mfma_f32_16x16x32_bf16 v[88:91], v[120:123], v[68:71], v[88:91]
    v_mfma_f32_16x16x32_bf16 v[92:95], v[124:127], v[68:71], v[92:95]
    v_mfma_f32_16x16x32_bf16 v[96:99], v[128:131], v[68:71], v[96:99]
    v_mfma_f32_16x16x32_bf16 v[100:103], v[132:135], v[68:71], v[100:103]
    ds_read_b64_tr_b16 v[120:121], v150 offset:13824
    ds_read_b64_tr_b16 v[122:123], v150 offset:14848
    ds_read_b64_tr_b16 v[124:125], v151 offset:13824
    ds_read_b64_tr_b16 v[126:127], v151 offset:14848
    ds_read_b64_tr_b16 v[128:129], v148 offset:13824
    ds_read_b64_tr_b16 v[130:131], v148 offset:14848
    ds_read_b64_tr_b16 v[132:133], v149 offset:13824
    ds_read_b64_tr_b16 v[134:135], v149 offset:14848
    s_waitcnt vmcnt(3)
    s_waitcnt lgkmcnt(8)
    v_mfma_f32_16x16x32_bf16 v[88:91], v[104:107], v[72:75], v[88:91]
    v_mfma_f32_16x16x32_bf16 v[92:95], v[108:111], v[72:75], v[92:95]
    v_mfma_f32_16x16x32_bf16 v[96:99], v[112:115], v[72:75], v[96:99]
    v_mfma_f32_16x16x32_bf16 v[100:103], v[116:119], v[72:75], v[100:103]
    ds_read_b64_tr_b16 v[104:105], v152 offset:0
    ds_read_b64_tr_b16 v[106:107], v154 offset:4608
    ds_read_b64_tr_b16 v[108:109], v153 offset:0
    ds_read_b64_tr_b16 v[110:111], v155 offset:4608
    ds_read_b64_tr_b16 v[112:113], v154 offset:0
    ds_read_b64_tr_b16 v[114:115], v152 offset:4608
    ds_read_b64_tr_b16 v[116:117], v155 offset:0
    ds_read_b64_tr_b16 v[118:119], v153 offset:4608
    s_waitcnt vmcnt(2)
    s_waitcnt lgkmcnt(8)
    v_mfma_f32_16x16x32_bf16 v[88:91], v[120:123], v[76:79], v[88:91]
    v_mfma_f32_16x16x32_bf16 v[92:95], v[124:127], v[76:79], v[92:95]
    v_mfma_f32_16x16x32_bf16 v[96:99], v[128:131], v[76:79], v[96:99]
    v_mfma_f32_16x16x32_bf16 v[100:103], v[132:135], v[76:79], v[100:103]
    ds_read_b64_tr_b16 v[120:121], v152 offset:36864
    ds_read_b64_tr_b16 v[122:123], v154 offset:41472
    ds_read_b64_tr_b16 v[124:125], v153 offset:36864
    ds_read_b64_tr_b16 v[126:127], v155 offset:41472
    ds_read_b64_tr_b16 v[128:129], v154 offset:36864
    ds_read_b64_tr_b16 v[130:131], v152 offset:41472
    ds_read_b64_tr_b16 v[132:133], v155 offset:36864
    ds_read_b64_tr_b16 v[134:135], v153 offset:41472
    s_waitcnt vmcnt(1)
    s_waitcnt lgkmcnt(8)
    v_mfma_f32_16x16x32_bf16 v[88:91], v[104:107], v[80:83], v[88:91]
    v_mfma_f32_16x16x32_bf16 v[92:95], v[108:111], v[80:83], v[92:95]
    v_mfma_f32_16x16x32_bf16 v[96:99], v[112:115], v[80:83], v[96:99]
    v_mfma_f32_16x16x32_bf16 v[100:103], v[116:119], v[80:83], v[100:103]
    s_waitcnt vmcnt(0)
    s_waitcnt lgkmcnt(0)
    v_mfma_f32_16x16x32_bf16 v[88:91], v[120:123], v[84:87], v[88:91]
    v_mfma_f32_16x16x32_bf16 v[92:95], v[124:127], v[84:87], v[92:95]
    v_mfma_f32_16x16x32_bf16 v[96:99], v[128:131], v[84:87], v[96:99]
    v_mfma_f32_16x16x32_bf16 v[100:103], v[132:135], v[84:87], v[100:103]
    s_nop 4
    v_cvt_pk_bf16_f32 v88, 0, v88
    v_cvt_pk_bf16_f32 v89, 0, v89
    v_cvt_pk_bf16_f32 v90, 0, v90
    v_cvt_pk_bf16_f32 v91, 0, v91
    v_mul_f32 v88, v88, v144
    v_mul_f32 v89, v89, v144
    v_mul_f32 v90, v90, v144
    v_mul_f32 v91, v91, v144
    v_cvt_pk_bf16_f32 v88, 0, v88
    v_cvt_pk_bf16_f32 v89, 0, v89
    v_cvt_pk_bf16_f32 v90, 0, v90
    v_cvt_pk_bf16_f32 v91, 0, v91
    v_add_f32 v88, v88, v156
    v_add_f32 v89, v89, v157
    v_add_f32 v90, v90, v158
    v_add_f32 v91, v91, v159
    v_cvt_pk_bf16_f32 v88, v88, v89
    v_cvt_pk_bf16_f32 v89, v90, v91
    buffer_store_dwordx2 v[88:89], v5, s[32:35], s57 offen offset:0
    v_cvt_pk_bf16_f32 v92, 0, v92
    v_cvt_pk_bf16_f32 v93, 0, v93
    v_cvt_pk_bf16_f32 v94, 0, v94
    v_cvt_pk_bf16_f32 v95, 0, v95
    v_mul_f32 v92, v92, v144
    v_mul_f32 v93, v93, v144
    v_mul_f32 v94, v94, v144
    v_mul_f32 v95, v95, v144
    v_cvt_pk_bf16_f32 v92, 0, v92
    v_cvt_pk_bf16_f32 v93, 0, v93
    v_cvt_pk_bf16_f32 v94, 0, v94
    v_cvt_pk_bf16_f32 v95, 0, v95
    v_add_f32 v92, v92, v160
    v_add_f32 v93, v93, v161
    v_add_f32 v94, v94, v162
    v_add_f32 v95, v95, v163
    v_cvt_pk_bf16_f32 v92, v92, v93
    v_cvt_pk_bf16_f32 v93, v94, v95
    buffer_store_dwordx2 v[92:93], v5, s[32:35], s57 offen offset:32
    v_cvt_pk_bf16_f32 v96, 0, v96
    v_cvt_pk_bf16_f32 v97, 0, v97
    v_cvt_pk_bf16_f32 v98, 0, v98
    v_cvt_pk_bf16_f32 v99, 0, v99
    v_mul_f32 v96, v96, v144
    v_mul_f32 v97, v97, v144
    v_mul_f32 v98, v98, v144
    v_mul_f32 v99, v99, v144
    v_cvt_pk_bf16_f32 v96, 0, v96
    v_cvt_pk_bf16_f32 v97, 0, v97
    v_cvt_pk_bf16_f32 v98, 0, v98
    v_cvt_pk_bf16_f32 v99, 0, v99
    v_add_f32 v96, v96, v164
    v_add_f32 v97, v97, v165
    v_add_f32 v98, v98, v166
    v_add_f32 v99, v99, v167
    v_cvt_pk_bf16_f32 v96, v96, v97
    v_cvt_pk_bf16_f32 v97, v98, v99
    buffer_store_dwordx2 v[96:97], v5, s[32:35], s57 offen offset:64
    v_cvt_pk_bf16_f32 v100, 0, v100
    v_cvt_pk_bf16_f32 v101, 0, v101
    v_cvt_pk_bf16_f32 v102, 0, v102
    v_cvt_pk_bf16_f32 v103, 0, v103
    v_mul_f32 v100, v100, v144
    v_mul_f32 v101, v101, v144
    v_mul_f32 v102, v102, v144
    v_mul_f32 v103, v103, v144
    v_cvt_pk_bf16_f32 v100, 0, v100
    v_cvt_pk_bf16_f32 v101, 0, v101
    v_cvt_pk_bf16_f32 v102, 0, v102
    v_cvt_pk_bf16_f32 v103, 0, v103
    v_add_f32 v100, v100, v168
    v_add_f32 v101, v101, v169
    v_add_f32 v102, v102, v170
    v_add_f32 v103, v103, v171
    v_cvt_pk_bf16_f32 v100, v100, v101
    v_cvt_pk_bf16_f32 v101, v102, v103
    buffer_store_dwordx2 v[100:101], v5, s[32:35], s57 offen offset:96
L_end:
    s_endpgm
L_fallback:
    v_cndmask_b32 v12, v12, 0, s[42:43]
    v_mov_b32 v14, 0xff800000
    ds_read_b64 v[16:17], v4 offset:2048
    ds_read_b64 v[18:19], v4 offset:5152
    ds_read_b64 v[20:21], v3 offset:2048
    s_mov_b32 s20, 0xffffffff
    s_mov_b32 s21, 0xfffffff0
    v_cndmask_b32 v44, v2, 0, s[20:21]
    s_mov_b32 s20, 0xfffffffe
    s_mov_b32 s21, 0xffffffe0
    v_cndmask_b32 v45, v2, 0, s[20:21]
    s_mov_b32 s20, 0xfffffffc
    s_mov_b32 s21, 0xffffffc0
    v_cndmask_b32 v46, v2, 0, s[20:21]
    s_mov_b32 s20, 0xfffffff8
    s_mov_b32 s21, 0xffffff80
    v_cndmask_b32 v47, v2, 0, s[20:21]
    s_mov_b32 s20, 0xffffff00
    s_mov_b32 s21, 0xfffff000
    v_cndmask_b32 v48, v2, 0, s[20:21]
    s_mov_b32 s20, 0xfffffe00
    s_mov_b32 s21, 0xffffe000
    v_cndmask_b32 v49, v2, 0, s[20:21]
    s_mov_b32 s20, 0xfffffc00
    s_mov_b32 s21, 0xffffc000
    v_cndmask_b32 v50, v2, 0, s[20:21]
    s_mov_b32 s20, 0xfffff800
    s_mov_b32 s21, 0xffff8000
    v_cndmask_b32 v51, v2, 0, s[20:21]
    s_mov_b32 s20, 0xffff0000
    s_mov_b32 s21, 0xfff00000
    v_cndmask_b32 v52, v2, 0, s[20:21]
    s_mov_b32 s20, 0xfffe0000
    s_mov_b32 s21, 0xffe00000
    v_cndmask_b32 v53, v2, 0, s[20:21]
    s_mov_b32 s20, 0xfffc0000
    s_mov_b32 s21, 0xffc00000
    v_cndmask_b32 v54, v2, 0, s[20:21]
    s_mov_b32 s20, 0xfff80000
    s_mov_b32 s21, 0xff800000
    v_cndmask_b32 v55, v2, 0, s[20:21]
    s_mov_b32 s20, 0xff000000
    s_mov_b32 s21, 0xf0000000
    v_cndmask_b32 v56, v2, 0, s[20:21]
    s_mov_b32 s20, 0xfe000000
    s_mov_b32 s21, 0xe0000000
    v_cndmask_b32 v57, v2, 0, s[20:21]
    s_mov_b32 s20, 0xfc000000
    s_mov_b32 s21, 0xc0000000
    v_cndmask_b32 v58, v2, 0, s[20:21]
    s_mov_b32 s20, 0xf8000000
    s_mov_b32 s21, 0x80000000
    v_cndmask_b32 v59, v2, 0, s[20:21]
    s_waitcnt lgkmcnt(0)
    s_nop 1
    v_mfma_f32_32x32x16_bf16 v[44:59], v[16:19], v[8:11], v[44:59]
    v_mfma_f32_32x32x8_bf16 v[44:59], v[20:21], v[12:13], v[44:59]
    s_nop 7
    s_nop 3
    v_max3_f32 v14, v44, v45, v14
    v_max3_f32 v14, v46, v47, v14
    v_max3_f32 v14, v48, v49, v14
    v_max3_f32 v14, v50, v51, v14
    v_max3_f32 v14, v52, v53, v14
    v_max3_f32 v14, v54, v55, v14
    v_max3_f32 v14, v56, v57, v14
    v_max3_f32 v14, v58, v59, v14
    ds_read_b64 v[22:23], v4 offset:1792
    ds_read_b64 v[24:25], v4 offset:4896
    ds_read_b64 v[26:27], v3 offset:1792
    s_cmp_lg_u32 s27, 8
    s_cbranch_scc1 sm_k7
    v_mov_b32 v6, 0xff7f
    v_cndmask_b32 v12, v12, v6, s[42:43]
sm_k7:
    s_waitcnt lgkmcnt(0)
    s_nop 1
    v_mfma_f32_32x32x16_bf16 v[60:75], v[22:25], v[8:11], 0
    v_mfma_f32_32x32x8_bf16 v[60:75], v[26:27], v[12:13], v[60:75]
    s_nop 7
    s_nop 3
    v_max3_f32 v14, v60, v61, v14
    v_max3_f32 v14, v62, v63, v14
    v_max3_f32 v14, v64, v65, v14
    v_max3_f32 v14, v66, v67, v14
    v_max3_f32 v14, v68, v69, v14
    v_max3_f32 v14, v70, v71, v14
    v_max3_f32 v14, v72, v73, v14
    v_max3_f32 v14, v74, v75, v14
    ds_read_b64 v[16:17], v4 offset:1536
    ds_read_b64 v[18:19], v4 offset:4640
    ds_read_b64 v[20:21], v3 offset:1536
    s_cmp_lg_u32 s27, 7
    s_cbranch_scc1 sm_k6
    v_mov_b32 v6, 0xff7f
    v_cndmask_b32 v12, v12, v6, s[42:43]
sm_k6:
    s_waitcnt lgkmcnt(0)
    s_nop 1
    v_mfma_f32_32x32x16_bf16 v[44:59], v[16:19], v[8:11], 0
    v_mfma_f32_32x32x8_bf16 v[44:59], v[20:21], v[12:13], v[44:59]
    s_nop 7
    s_nop 3
    v_max3_f32 v14, v44, v45, v14
    v_max3_f32 v14, v46, v47, v14
    v_max3_f32 v14, v48, v49, v14
    v_max3_f32 v14, v50, v51, v14
    v_max3_f32 v14, v52, v53, v14
    v_max3_f32 v14, v54, v55, v14
    v_max3_f32 v14, v56, v57, v14
    v_max3_f32 v14, v58, v59, v14
    ds_read_b64 v[22:23], v4 offset:1280
    ds_read_b64 v[24:25], v4 offset:4384
    ds_read_b64 v[26:27], v3 offset:1280
    s_cmp_lg_u32 s27, 6
    s_cbranch_scc1 sm_k5
    v_mov_b32 v6, 0xff7f
    v_cndmask_b32 v12, v12, v6, s[42:43]
sm_k5:
    s_waitcnt lgkmcnt(0)
    s_nop 1
    v_mfma_f32_32x32x16_bf16 v[60:75], v[22:25], v[8:11], 0
    v_mfma_f32_32x32x8_bf16 v[60:75], v[26:27], v[12:13], v[60:75]
    s_nop 7
    s_nop 3
    v_max3_f32 v14, v60, v61, v14
    v_max3_f32 v14, v62, v63, v14
    v_max3_f32 v14, v64, v65, v14
    v_max3_f32 v14, v66, v67, v14
    v_max3_f32 v14, v68, v69, v14
    v_max3_f32 v14, v70, v71, v14
    v_max3_f32 v14, v72, v73, v14
    v_max3_f32 v14, v74, v75, v14
    ds_read_b64 v[16:17], v4 offset:1024
    ds_read_b64 v[18:19], v4 offset:4128
    ds_read_b64 v[20:21], v3 offset:1024
    s_cmp_lg_u32 s27, 5
    s_cbranch_scc1 sm_k4
    v_mov_b32 v6, 0xff7f
    v_cndmask_b32 v12, v12, v6, s[42:43]
sm_k4:
    s_waitcnt lgkmcnt(0)
    s_nop 1
    v_mfma_f32_32x32x16_bf16 v[44:59], v[16:19], v[8:11], 0
    v_mfma_f32_32x32x8_bf16 v[44:59], v[20:21], v[12:13], v[44:59]
    s_nop 7
    s_nop 3
    v_max3_f32 v14, v44, v45, v14
    v_max3_f32 v14, v46, v47, v14
    v_max3_f32 v14, v48, v49, v14
    v_max3_f32 v14, v50, v51, v14
    v_max3_f32 v14, v52, v53, v14
    v_max3_f32 v14, v54, v55, v14
    v_max3_f32 v14, v56, v57, v14
    v_max3_f32 v14, v58, v59, v14
    ds_read_b64 v[22:23], v4 offset:768
    ds_read_b64 v[24:25], v4 offset:3872
    ds_read_b64 v[26:27], v3 offset:768
    s_cmp_lg_u32 s27, 4
    s_cbranch_scc1 sm_k3
    v_mov_b32 v6, 0xff7f
    v_cndmask_b32 v12, v12, v6, s[42:43]
sm_k3:
    s_waitcnt lgkmcnt(0)
    s_nop 1
    v_mfma_f32_32x32x16_bf16 v[60:75], v[22:25], v[8:11], 0
    v_mfma_f32_32x32x8_bf16 v[60:75], v[26:27], v[12:13], v[60:75]
    s_nop 7
    s_nop 3
    v_max3_f32 v14, v60, v61, v14
    v_max3_f32 v14, v62, v63, v14
    v_max3_f32 v14, v64, v65, v14
    v_max3_f32 v14, v66, v67, v14
    v_max3_f32 v14, v68, v69, v14
    v_max3_f32 v14, v70, v71, v14
    v_max3_f32 v14, v72, v73, v14
    v_max3_f32 v14, v74, v75, v14
    ds_read_b64 v[16:17], v4 offset:512
    ds_read_b64 v[18:19], v4 offset:3616
    ds_read_b64 v[20:21], v3 offset:512
    s_cmp_lg_u32 s27, 3
    s_cbranch_scc1 sm_k2
    v_mov_b32 v6, 0xff7f
    v_cndmask_b32 v12, v12, v6, s[42:43]
sm_k2:
    s_waitcnt lgkmcnt(0)
    s_nop 1
    v_mfma_f32_32x32x16_bf16 v[44:59], v[16:19], v[8:11], 0
    v_mfma_f32_32x32x8_bf16 v[44:59], v[20:21], v[12:13], v[44:59]
    s_nop 7
    s_nop 3
    v_max3_f32 v14, v44, v45, v14
    v_max3_f32 v14, v46, v47, v14
    v_max3_f32 v14, v48, v49, v14
    v_max3_f32 v14, v50, v51, v14
    v_max3_f32 v14, v52, v53, v14
    v_max3_f32 v14, v54, v55, v14
    v_max3_f32 v14, v56, v57, v14
    v_max3_f32 v14, v58, v59, v14
    ds_read_b64 v[22:23], v4 offset:256
    ds_read_b64 v[24:25], v4 offset:3360
    ds_read_b64 v[26:27], v3 offset:256
    s_cmp_lg_u32 s27, 2
    s_cbranch_scc1 sm_k1
    v_mov_b32 v6, 0xff7f
    v_cndmask_b32 v12, v12, v6, s[42:43]
sm_k1:
    s_waitcnt lgkmcnt(0)
    s_nop 1
    v_mfma_f32_32x32x16_bf16 v[60:75], v[22:25], v[8:11], 0
    v_mfma_f32_32x32x8_bf16 v[60:75], v[26:27], v[12:13], v[60:75]
    s_nop 7
    s_nop 3
    v_max3_f32 v14, v60, v61, v14
    v_max3_f32 v14, v62, v63, v14
    v_max3_f32 v14, v64, v65, v14
    v_max3_f32 v14, v66, v67, v14
    v_max3_f32 v14, v68, v69, v14
    v_max3_f32 v14, v70, v71, v14
    v_max3_f32 v14, v72, v73, v14
    v_max3_f32 v14, v74, v75, v14
    ds_read_b64 v[16:17], v4 offset:0
    ds_read_b64 v[18:19], v4 offset:3104
    ds_read_b64 v[20:21], v3 offset:0
    s_cmp_lg_u32 s27, 1
    s_cbranch_scc1 sm_k0
    v_mov_b32 v6, 0xff7f
    v_cndmask_b32 v12, v12, v6, s[42:43]
sm_k0:
    s_waitcnt lgkmcnt(0)
    s_nop 1
    v_mfma_f32_32x32x16_bf16 v[44:59], v[16:19], v[8:11], v[144:159]
    v_mfma_f32_32x32x8_bf16 v[44:59], v[20:21], v[12:13], v[44:59]
    s_nop 7
    s_nop 3
    v_max3_f32 v14, v44, v45, v14
    v_max3_f32 v14, v46, v47, v14
    v_max3_f32 v14, v48, v49, v14
    v_max3_f32 v14, v50, v51, v14
    v_max3_f32 v14, v52, v53, v14
    v_max3_f32 v14, v54, v55, v14
    v_max3_f32 v14, v56, v57, v14
    v_max3_f32 v14, v58, v59, v14
    ds_read_b64 v[16:17], v4 offset:2048
    ds_read_b64 v[18:19], v4 offset:5152
    ds_read_b64 v[20:21], v3 offset:2048
    ds_read_b64 v[22:23], v4 offset:1792
    ds_read_b64 v[24:25], v4 offset:4896
    ds_read_b64 v[26:27], v3 offset:1792
    v_cndmask_b32 v12, v12, 0, s[42:43]
    v_mov_b32 v7, v14
    s_nop 1
    v_permlane32_swap_b32 v14, v7
    s_nop 1
    v_max_f32 v14, v14, v7
    v_sub_f32 v14, 0, v14
    s_mov_b32 s20, 0xffffffff
    s_mov_b32 s21, 0xfffffff0
    v_cndmask_b32 v44, v2, 0, s[20:21]
    s_mov_b32 s20, 0xfffffffe
    s_mov_b32 s21, 0xffffffe0
    v_cndmask_b32 v45, v2, 0, s[20:21]
    s_mov_b32 s20, 0xfffffffc
    s_mov_b32 s21, 0xffffffc0
    v_cndmask_b32 v46, v2, 0, s[20:21]
    s_mov_b32 s20, 0xfffffff8
    s_mov_b32 s21, 0xffffff80
    v_cndmask_b32 v47, v2, 0, s[20:21]
    s_mov_b32 s20, 0xffffff00
    s_mov_b32 s21, 0xfffff000
    v_cndmask_b32 v48, v2, 0, s[20:21]
    s_mov_b32 s20, 0xfffffe00
    s_mov_b32 s21, 0xffffe000
    v_cndmask_b32 v49, v2, 0, s[20:21]
    s_mov_b32 s20, 0xfffffc00
    s_mov_b32 s21, 0xffffc000
    v_cndmask_b32 v50, v2, 0, s[20:21]
    s_mov_b32 s20, 0xfffff800
    s_mov_b32 s21, 0xffff8000
    v_cndmask_b32 v51, v2, 0, s[20:21]
    s_mov_b32 s20, 0xffff0000
    s_mov_b32 s21, 0xfff00000
    v_cndmask_b32 v52, v2, 0, s[20:21]
    s_mov_b32 s20, 0xfffe0000
    s_mov_b32 s21, 0xffe00000
    v_cndmask_b32 v53, v2, 0, s[20:21]
    s_mov_b32 s20, 0xfffc0000
    s_mov_b32 s21, 0xffc00000
    v_cndmask_b32 v54, v2, 0, s[20:21]
    s_mov_b32 s20, 0xfff80000
    s_mov_b32 s21, 0xff800000
    v_cndmask_b32 v55, v2, 0, s[20:21]
    s_mov_b32 s20, 0xff000000
    s_mov_b32 s21, 0xf0000000
    v_cndmask_b32 v56, v2, 0, s[20:21]
    s_mov_b32 s20, 0xfe000000
    s_mov_b32 s21, 0xe0000000
    v_cndmask_b32 v57, v2, 0, s[20:21]
    s_mov_b32 s20, 0xfc000000
    s_mov_b32 s21, 0xc0000000
    v_cndmask_b32 v58, v2, 0, s[20:21]
    s_mov_b32 s20, 0xf8000000
    s_mov_b32 s21, 0x80000000
    v_cndmask_b32 v59, v2, 0, s[20:21]
    s_waitcnt lgkmcnt(3)
    s_nop 1
    v_mfma_f32_32x32x16_bf16 v[44:59], v[16:19], v[8:11], v[44:59]
    v_mfma_f32_32x32x8_bf16 v[44:59], v[20:21], v[12:13], v[44:59]
    ds_read_b64_tr_b16 v[28:29], v5 offset:2048
    ds_read_b64_tr_b16 v[30:31], v5 offset:2112
    ds_read_b64_tr_b16 v[32:33], v5 offset:2176
    ds_read_b64_tr_b16 v[34:35], v5 offset:2240
    s_cmp_lg_u32 s27, 8
    s_cbranch_scc1 sb_k7
    v_mov_b32 v6, 0xff7f
    v_cndmask_b32 v12, v12, v6, s[42:43]
sb_k7:
    s_nop 3
    s_waitcnt lgkmcnt(4)
    v_mfma_f32_32x32x16_bf16 v[60:75], v[22:25], v[8:11], 0
    v_add_f32 v44, v44, v14
    v_exp_f32 v44, v44
    v_add_f32 v45, v45, v14
    v_exp_f32 v45, v45
    v_add_f32 v46, v46, v14
    v_exp_f32 v46, v46
    v_add_f32 v47, v47, v14
    v_exp_f32 v47, v47
    v_cvt_pk_bf16_f32 v76, v44, v45
    v_add_f32 v48, v48, v14
    v_mfma_f32_32x32x8_bf16 v[60:75], v[26:27], v[12:13], v[60:75]
    ds_read_b64 v[16:17], v4 offset:1536
    ds_read_b64 v[18:19], v4 offset:4640
    ds_read_b64 v[20:21], v3 offset:1536
    s_cmp_lg_u32 s27, 7
    s_cbranch_scc1 sb_k6
    v_mov_b32 v6, 0xff7f
    v_cndmask_b32 v12, v12, v6, s[42:43]
sb_k6:
    v_exp_f32 v48, v48
    v_add_f32 v49, v49, v14
    v_exp_f32 v49, v49
    v_cvt_pk_bf16_f32 v77, v46, v47
    v_add_f32 v50, v50, v14
    v_exp_f32 v50, v50
    v_add_f32 v51, v51, v14
    v_exp_f32 v51, v51
    v_cvt_pk_bf16_f32 v78, v48, v49
    v_add_f32 v52, v52, v14
    v_exp_f32 v52, v52
    v_add_f32 v53, v53, v14
    v_exp_f32 v53, v53
    v_cvt_pk_bf16_f32 v79, v50, v51
    v_add_f32 v54, v54, v14
    v_exp_f32 v54, v54
    v_add_f32 v55, v55, v14
    v_exp_f32 v55, v55
    v_cvt_pk_bf16_f32 v80, v52, v53
    v_add_f32 v56, v56, v14
    ds_read_b64_tr_b16 v[36:37], v5 offset:1792
    ds_read_b64_tr_b16 v[38:39], v5 offset:1856
    ds_read_b64_tr_b16 v[40:41], v5 offset:1920
    ds_read_b64_tr_b16 v[42:43], v5 offset:1984
    v_exp_f32 v56, v56
    v_add_f32 v57, v57, v14
    v_exp_f32 v57, v57
    v_cvt_pk_bf16_f32 v81, v54, v55
    v_add_f32 v58, v58, v14
    v_exp_f32 v58, v58
    v_add_f32 v59, v59, v14
    v_exp_f32 v59, v59
    v_cvt_pk_bf16_f32 v82, v56, v57
    s_nop 0
    v_cvt_pk_bf16_f32 v83, v58, v59
    s_waitcnt lgkmcnt(4)
    v_mfma_f32_32x32x16_bf16 v[44:59], v[16:19], v[8:11], 0
    v_add_f32 v60, v60, v14
    v_exp_f32 v60, v60
    v_add_f32 v61, v61, v14
    v_exp_f32 v61, v61
    v_add_f32 v62, v62, v14
    v_exp_f32 v62, v62
    v_add_f32 v63, v63, v14
    v_exp_f32 v63, v63
    v_cvt_pk_bf16_f32 v84, v60, v61
    v_add_f32 v64, v64, v14
    v_mfma_f32_32x32x8_bf16 v[44:59], v[20:21], v[12:13], v[44:59]
    ds_read_b64 v[22:23], v4 offset:1280
    ds_read_b64 v[24:25], v4 offset:4384
    ds_read_b64 v[26:27], v3 offset:1280
    s_cmp_lg_u32 s27, 6
    s_cbranch_scc1 sb_k5
    v_mov_b32 v6, 0xff7f
    v_cndmask_b32 v12, v12, v6, s[42:43]
sb_k5:
    v_exp_f32 v64, v64
    v_add_f32 v65, v65, v14
    v_exp_f32 v65, v65
    v_cvt_pk_bf16_f32 v85, v62, v63
    v_add_f32 v66, v66, v14
    v_exp_f32 v66, v66
    v_add_f32 v67, v67, v14
    v_exp_f32 v67, v67
    v_cvt_pk_bf16_f32 v86, v64, v65
    v_add_f32 v68, v68, v14
    v_mfma_f32_32x32x16_bf16 v[92:107], v[28:31], v[76:79], 0
    v_exp_f32 v68, v68
    v_add_f32 v69, v69, v14
    v_exp_f32 v69, v69
    v_cvt_pk_bf16_f32 v87, v66, v67
    v_add_f32 v70, v70, v14
    v_exp_f32 v70, v70
    v_add_f32 v71, v71, v14
    v_exp_f32 v71, v71
    v_cvt_pk_bf16_f32 v88, v68, v69
    v_add_f32 v72, v72, v14
    v_mfma_f32_32x32x16_bf16 v[92:107], v[32:35], v[80:83], v[92:107]
    ds_read_b64_tr_b16 v[28:29], v5 offset:1536
    ds_read_b64_tr_b16 v[30:31], v5 offset:1600
    ds_read_b64_tr_b16 v[32:33], v5 offset:1664
    ds_read_b64_tr_b16 v[34:35], v5 offset:1728
    v_exp_f32 v72, v72
    v_add_f32 v73, v73, v14
    v_exp_f32 v73, v73
    v_cvt_pk_bf16_f32 v89, v70, v71
    v_add_f32 v74, v74, v14
    v_exp_f32 v74, v74
    v_add_f32 v75, v75, v14
    v_exp_f32 v75, v75
    v_cvt_pk_bf16_f32 v90, v72, v73
    s_nop 0
    v_cvt_pk_bf16_f32 v91, v74, v75
    s_waitcnt lgkmcnt(4)
    v_mfma_f32_32x32x16_bf16 v[60:75], v[22:25], v[8:11], 0
    v_add_f32 v44, v44, v14
    v_exp_f32 v44, v44
    v_add_f32 v45, v45, v14
    v_exp_f32 v45, v45
    v_add_f32 v46, v46, v14
    v_exp_f32 v46, v46
    v_add_f32 v47, v47, v14
    v_exp_f32 v47, v47
    v_cvt_pk_bf16_f32 v76, v44, v45
    v_add_f32 v48, v48, v14
    v_mfma_f32_32x32x8_bf16 v[60:75], v[26:27], v[12:13], v[60:75]
    ds_read_b64 v[16:17], v4 offset:1024
    ds_read_b64 v[18:19], v4 offset:4128
    ds_read_b64 v[20:21], v3 offset:1024
    s_cmp_lg_u32 s27, 5
    s_cbranch_scc1 sb_k4
    v_mov_b32 v6, 0xff7f
    v_cndmask_b32 v12, v12, v6, s[42:43]
sb_k4:
    v_exp_f32 v48, v48
    v_add_f32 v49, v49, v14
    v_exp_f32 v49, v49
    v_cvt_pk_bf16_f32 v77, v46, v47
    v_add_f32 v50, v50, v14
    v_exp_f32 v50, v50
    v_add_f32 v51, v51, v14
    v_exp_f32 v51, v51
    v_cvt_pk_bf16_f32 v78, v48, v49
    v_add_f32 v52, v52, v14
    v_mfma_f32_32x32x16_bf16 v[92:107], v[36:39], v[84:87], v[92:107]
    v_exp_f32 v52, v52
    v_add_f32 v53, v53, v14
    v_exp_f32 v53, v53
    v_cvt_pk_bf16_f32 v79, v50, v51
    v_add_f32 v54, v54, v14
    v_exp_f32 v54, v54
    v_add_f32 v55, v55, v14
    v_exp_f32 v55, v55
    v_cvt_pk_bf16_f32 v80, v52, v53
    v_add_f32 v56, v56, v14
    v_mfma_f32_32x32x16_bf16 v[92:107], v[40:43], v[88:91], v[92:107]
    ds_read_b64_tr_b16 v[36:37], v5 offset:1280
    ds_read_b64_tr_b16 v[38:39], v5 offset:1344
    ds_read_b64_tr_b16 v[40:41], v5 offset:1408
    ds_read_b64_tr_b16 v[42:43], v5 offset:1472
    v_exp_f32 v56, v56
    v_add_f32 v57, v57, v14
    v_exp_f32 v57, v57
    v_cvt_pk_bf16_f32 v81, v54, v55
    v_add_f32 v58, v58, v14
    v_exp_f32 v58, v58
    v_add_f32 v59, v59, v14
    v_exp_f32 v59, v59
    v_cvt_pk_bf16_f32 v82, v56, v57
    s_nop 0
    v_cvt_pk_bf16_f32 v83, v58, v59
    s_waitcnt lgkmcnt(4)
    v_mfma_f32_32x32x16_bf16 v[44:59], v[16:19], v[8:11], 0
    v_add_f32 v60, v60, v14
    v_exp_f32 v60, v60
    v_add_f32 v61, v61, v14
    v_exp_f32 v61, v61
    v_add_f32 v62, v62, v14
    v_exp_f32 v62, v62
    v_add_f32 v63, v63, v14
    v_exp_f32 v63, v63
    v_cvt_pk_bf16_f32 v84, v60, v61
    v_add_f32 v64, v64, v14
    v_mfma_f32_32x32x8_bf16 v[44:59], v[20:21], v[12:13], v[44:59]
    ds_read_b64 v[22:23], v4 offset:768
    ds_read_b64 v[24:25], v4 offset:3872
    ds_read_b64 v[26:27], v3 offset:768
    s_cmp_lg_u32 s27, 4
    s_cbranch_scc1 sb_k3
    v_mov_b32 v6, 0xff7f
    v_cndmask_b32 v12, v12, v6, s[42:43]
sb_k3:
    v_exp_f32 v64, v64
    v_add_f32 v65, v65, v14
    v_exp_f32 v65, v65
    v_cvt_pk_bf16_f32 v85, v62, v63
    v_add_f32 v66, v66, v14
    v_exp_f32 v66, v66
    v_add_f32 v67, v67, v14
    v_exp_f32 v67, v67
    v_cvt_pk_bf16_f32 v86, v64, v65
    v_add_f32 v68, v68, v14
    v_mfma_f32_32x32x16_bf16 v[92:107], v[28:31], v[76:79], v[92:107]
    v_exp_f32 v68, v68
    v_add_f32 v69, v69, v14
    v_exp_f32 v69, v69
    v_cvt_pk_bf16_f32 v87, v66, v67
    v_add_f32 v70, v70, v14
    v_exp_f32 v70, v70
    v_add_f32 v71, v71, v14
    v_exp_f32 v71, v71
    v_cvt_pk_bf16_f32 v88, v68, v69
    v_add_f32 v72, v72, v14
    v_mfma_f32_32x32x16_bf16 v[92:107], v[32:35], v[80:83], v[92:107]
    ds_read_b64_tr_b16 v[28:29], v5 offset:1024
    ds_read_b64_tr_b16 v[30:31], v5 offset:1088
    ds_read_b64_tr_b16 v[32:33], v5 offset:1152
    ds_read_b64_tr_b16 v[34:35], v5 offset:1216
    v_exp_f32 v72, v72
    v_add_f32 v73, v73, v14
    v_exp_f32 v73, v73
    v_cvt_pk_bf16_f32 v89, v70, v71
    v_add_f32 v74, v74, v14
    v_exp_f32 v74, v74
    v_add_f32 v75, v75, v14
    v_exp_f32 v75, v75
    v_cvt_pk_bf16_f32 v90, v72, v73
    s_nop 0
    v_cvt_pk_bf16_f32 v91, v74, v75
    s_waitcnt lgkmcnt(4)
    v_mfma_f32_32x32x16_bf16 v[60:75], v[22:25], v[8:11], 0
    v_add_f32 v44, v44, v14
    v_exp_f32 v44, v44
    v_add_f32 v45, v45, v14
    v_exp_f32 v45, v45
    v_add_f32 v46, v46, v14
    v_exp_f32 v46, v46
    v_add_f32 v47, v47, v14
    v_exp_f32 v47, v47
    v_cvt_pk_bf16_f32 v76, v44, v45
    v_add_f32 v48, v48, v14
    v_mfma_f32_32x32x8_bf16 v[60:75], v[26:27], v[12:13], v[60:75]
    ds_read_b64 v[16:17], v4 offset:512
    ds_read_b64 v[18:19], v4 offset:3616
    ds_read_b64 v[20:21], v3 offset:512
    s_cmp_lg_u32 s27, 3
    s_cbranch_scc1 sb_k2
    v_mov_b32 v6, 0xff7f
    v_cndmask_b32 v12, v12, v6, s[42:43]
sb_k2:
    v_exp_f32 v48, v48
    v_add_f32 v49, v49, v14
    v_exp_f32 v49, v49
    v_cvt_pk_bf16_f32 v77, v46, v47
    v_add_f32 v50, v50, v14
    v_exp_f32 v50, v50
    v_add_f32 v51, v51, v14
    v_exp_f32 v51, v51
    v_cvt_pk_bf16_f32 v78, v48, v49
    v_add_f32 v52, v52, v14
    v_mfma_f32_32x32x16_bf16 v[92:107], v[36:39], v[84:87], v[92:107]
    v_exp_f32 v52, v52
    v_add_f32 v53, v53, v14
    v_exp_f32 v53, v53
    v_cvt_pk_bf16_f32 v79, v50, v51
    v_add_f32 v54, v54, v14
    v_exp_f32 v54, v54
    v_add_f32 v55, v55, v14
    v_exp_f32 v55, v55
    v_cvt_pk_bf16_f32 v80, v52, v53
    v_add_f32 v56, v56, v14
    v_mfma_f32_32x32x16_bf16 v[92:107], v[40:43], v[88:91], v[92:107]
    ds_read_b64_tr_b16 v[36:37], v5 offset:768
    ds_read_b64_tr_b16 v[38:39], v5 offset:832
    ds_read_b64_tr_b16 v[40:41], v5 offset:896
    ds_read_b64_tr_b16 v[42:43], v5 offset:960
    v_exp_f32 v56, v56
    v_add_f32 v57, v57, v14
    v_exp_f32 v57, v57
    v_cvt_pk_bf16_f32 v81, v54, v55
    v_add_f32 v58, v58, v14
    v_exp_f32 v58, v58
    v_add_f32 v59, v59, v14
    v_exp_f32 v59, v59
    v_cvt_pk_bf16_f32 v82, v56, v57
    s_nop 0
    v_cvt_pk_bf16_f32 v83, v58, v59
    s_waitcnt lgkmcnt(4)
    v_mfma_f32_32x32x16_bf16 v[44:59], v[16:19], v[8:11], 0
    v_add_f32 v60, v60, v14
    v_exp_f32 v60, v60
    v_add_f32 v61, v61, v14
    v_exp_f32 v61, v61
    v_add_f32 v62, v62, v14
    v_exp_f32 v62, v62
    v_add_f32 v63, v63, v14
    v_exp_f32 v63, v63
    v_cvt_pk_bf16_f32 v84, v60, v61
    v_add_f32 v64, v64, v14
    v_mfma_f32_32x32x8_bf16 v[44:59], v[20:21], v[12:13], v[44:59]
    ds_read_b64 v[22:23], v4 offset:256
    ds_read_b64 v[24:25], v4 offset:3360
    ds_read_b64 v[26:27], v3 offset:256
    s_cmp_lg_u32 s27, 2
    s_cbranch_scc1 sb_k1
    v_mov_b32 v6, 0xff7f
    v_cndmask_b32 v12, v12, v6, s[42:43]
sb_k1:
    v_exp_f32 v64, v64
    v_add_f32 v65, v65, v14
    v_exp_f32 v65, v65
    v_cvt_pk_bf16_f32 v85, v62, v63
    v_add_f32 v66, v66, v14
    v_exp_f32 v66, v66
    v_add_f32 v67, v67, v14
    v_exp_f32 v67, v67
    v_cvt_pk_bf16_f32 v86, v64, v65
    v_add_f32 v68, v68, v14
    v_mfma_f32_32x32x16_bf16 v[92:107], v[28:31], v[76:79], v[92:107]
    v_exp_f32 v68, v68
    v_add_f32 v69, v69, v14
    v_exp_f32 v69, v69
    v_cvt_pk_bf16_f32 v87, v66, v67
    v_add_f32 v70, v70, v14
    v_exp_f32 v70, v70
    v_add_f32 v71, v71, v14
    v_exp_f32 v71, v71
    v_cvt_pk_bf16_f32 v88, v68, v69
    v_add_f32 v72, v72, v14
    v_mfma_f32_32x32x16_bf16 v[92:107], v[32:35], v[80:83], v[92:107]
    ds_read_b64_tr_b16 v[28:29], v5 offset:512
    ds_read_b64_tr_b16 v[30:31], v5 offset:576
    ds_read_b64_tr_b16 v[32:33], v5 offset:640
    ds_read_b64_tr_b16 v[34:35], v5 offset:704
    v_exp_f32 v72, v72
    v_add_f32 v73, v73, v14
    v_exp_f32 v73, v73
    v_cvt_pk_bf16_f32 v89, v70, v71
    v_add_f32 v74, v74, v14
    v_exp_f32 v74, v74
    v_add_f32 v75, v75, v14
    v_exp_f32 v75, v75
    v_cvt_pk_bf16_f32 v90, v72, v73
    s_nop 0
    v_cvt_pk_bf16_f32 v91, v74, v75
    s_waitcnt lgkmcnt(4)
    v_mfma_f32_32x32x16_bf16 v[60:75], v[22:25], v[8:11], 0
    v_add_f32 v44, v44, v14
    v_exp_f32 v44, v44
    v_add_f32 v45, v45, v14
    v_exp_f32 v45, v45
    v_add_f32 v46, v46, v14
    v_exp_f32 v46, v46
    v_add_f32 v47, v47, v14
    v_exp_f32 v47, v47
    v_cvt_pk_bf16_f32 v76, v44, v45
    v_add_f32 v48, v48, v14
    v_mfma_f32_32x32x8_bf16 v[60:75], v[26:27], v[12:13], v[60:75]
    ds_read_b64 v[16:17], v4 offset:0
    ds_read_b64 v[18:19], v4 offset:3104
    ds_read_b64 v[20:21], v3 offset:0
    s_cmp_lg_u32 s27, 1
    s_cbranch_scc1 sb_k0
    v_mov_b32 v6, 0xff7f
    v_cndmask_b32 v12, v12, v6, s[42:43]
sb_k0:
    v_exp_f32 v48, v48
    v_add_f32 v49, v49, v14
    v_exp_f32 v49, v49
    v_cvt_pk_bf16_f32 v77, v46, v47
    v_add_f32 v50, v50, v14
    v_exp_f32 v50, v50
    v_add_f32 v51, v51, v14
    v_exp_f32 v51, v51
    v_cvt_pk_bf16_f32 v78, v48, v49
    v_add_f32 v52, v52, v14
    v_mfma_f32_32x32x16_bf16 v[92:107], v[36:39], v[84:87], v[92:107]
    v_exp_f32 v52, v52
    v_add_f32 v53, v53, v14
    v_exp_f32 v53, v53
    v_cvt_pk_bf16_f32 v79, v50, v51
    v_add_f32 v54, v54, v14
    v_exp_f32 v54, v54
    v_add_f32 v55, v55, v14
    v_exp_f32 v55, v55
    v_cvt_pk_bf16_f32 v80, v52, v53
    v_add_f32 v56, v56, v14
    v_mfma_f32_32x32x16_bf16 v[92:107], v[40:43], v[88:91], v[92:107]
    ds_read_b64_tr_b16 v[36:37], v5 offset:256
    ds_read_b64_tr_b16 v[38:39], v5 offset:320
    ds_read_b64_tr_b16 v[40:41], v5 offset:384
    ds_read_b64_tr_b16 v[42:43], v5 offset:448
    v_exp_f32 v56, v56
    v_add_f32 v57, v57, v14
    v_exp_f32 v57, v57
    v_cvt_pk_bf16_f32 v81, v54, v55
    v_add_f32 v58, v58, v14
    v_exp_f32 v58, v58
    v_add_f32 v59, v59, v14
    v_exp_f32 v59, v59
    v_cvt_pk_bf16_f32 v82, v56, v57
    s_nop 0
    v_cvt_pk_bf16_f32 v83, v58, v59
    s_waitcnt lgkmcnt(4)
    v_mfma_f32_32x32x16_bf16 v[44:59], v[16:19], v[8:11], v[144:159]
    v_add_f32 v60, v60, v14
    v_exp_f32 v60, v60
    v_add_f32 v61, v61, v14
    v_exp_f32 v61, v61
    v_add_f32 v62, v62, v14
    v_exp_f32 v62, v62
    v_add_f32 v63, v63, v14
    v_exp_f32 v63, v63
    v_cvt_pk_bf16_f32 v84, v60, v61
    v_add_f32 v64, v64, v14
    v_mfma_f32_32x32x8_bf16 v[44:59], v[20:21], v[12:13], v[44:59]
    v_exp_f32 v64, v64
    v_add_f32 v65, v65, v14
    v_exp_f32 v65, v65
    v_cvt_pk_bf16_f32 v85, v62, v63
    v_add_f32 v66, v66, v14
    v_exp_f32 v66, v66
    v_add_f32 v67, v67, v14
    v_exp_f32 v67, v67
    v_cvt_pk_bf16_f32 v86, v64, v65
    v_add_f32 v68, v68, v14
    v_mfma_f32_32x32x16_bf16 v[92:107], v[28:31], v[76:79], v[92:107]
    v_exp_f32 v68, v68
    v_add_f32 v69, v69, v14
    v_exp_f32 v69, v69
    v_cvt_pk_bf16_f32 v87, v66, v67
    v_add_f32 v70, v70, v14
    v_exp_f32 v70, v70
    v_add_f32 v71, v71, v14
    v_exp_f32 v71, v71
    v_cvt_pk_bf16_f32 v88, v68, v69
    v_add_f32 v72, v72, v14
    v_mfma_f32_32x32x16_bf16 v[92:107], v[32:35], v[80:83], v[92:107]
    ds_read_b64_tr_b16 v[28:29], v5 offset:0
    ds_read_b64_tr_b16 v[30:31], v5 offset:64
    ds_read_b64_tr_b16 v[32:33], v5 offset:128
    ds_read_b64_tr_b16 v[34:35], v5 offset:192
    v_exp_f32 v72, v72
    v_add_f32 v73, v73, v14
    v_exp_f32 v73, v73
    v_cvt_pk_bf16_f32 v89, v70, v71
    v_add_f32 v74, v74, v14
    v_exp_f32 v74, v74
    v_add_f32 v75, v75, v14
    v_exp_f32 v75, v75
    v_cvt_pk_bf16_f32 v90, v72, v73
    s_nop 0
    v_cvt_pk_bf16_f32 v91, v74, v75
    s_nop 3
    v_add_f32 v44, v44, v14
    v_exp_f32 v44, v44
    v_add_f32 v45, v45, v14
    v_exp_f32 v45, v45
    v_add_f32 v46, v46, v14
    v_exp_f32 v46, v46
    v_add_f32 v47, v47, v14
    v_exp_f32 v47, v47
    v_cvt_pk_bf16_f32 v76, v44, v45
    v_add_f32 v48, v48, v14
    v_exp_f32 v48, v48
    v_add_f32 v49, v49, v14
    v_exp_f32 v49, v49
    v_cvt_pk_bf16_f32 v77, v46, v47
    v_add_f32 v50, v50, v14
    v_exp_f32 v50, v50
    v_add_f32 v51, v51, v14
    v_exp_f32 v51, v51
    v_cvt_pk_bf16_f32 v78, v48, v49
    v_add_f32 v52, v52, v14
    s_waitcnt lgkmcnt(4)
    v_mfma_f32_32x32x16_bf16 v[92:107], v[36:39], v[84:87], v[92:107]
    v_exp_f32 v52, v52
    v_add_f32 v53, v53, v14
    v_exp_f32 v53, v53
    v_cvt_pk_bf16_f32 v79, v50, v51
    v_add_f32 v54, v54, v14
    v_exp_f32 v54, v54
    v_add_f32 v55, v55, v14
    v_exp_f32 v55, v55
    v_cvt_pk_bf16_f32 v80, v52, v53
    v_add_f32 v56, v56, v14
    v_mfma_f32_32x32x16_bf16 v[92:107], v[40:43], v[88:91], v[92:107]
    v_exp_f32 v56, v56
    v_add_f32 v57, v57, v14
    v_exp_f32 v57, v57
    v_cvt_pk_bf16_f32 v81, v54, v55
    v_add_f32 v58, v58, v14
    v_exp_f32 v58, v58
    v_add_f32 v59, v59, v14
    v_exp_f32 v59, v59
    v_cvt_pk_bf16_f32 v82, v56, v57
    s_nop 0
    v_cvt_pk_bf16_f32 v83, v58, v59
    s_waitcnt lgkmcnt(0)
    s_nop 0
    v_mfma_f32_32x32x16_bf16 v[92:107], v[28:31], v[76:79], v[92:107]
    v_mfma_f32_32x32x16_bf16 v[92:107], v[32:35], v[80:83], v[92:107]
    s_nop 7
    s_nop 3
    s_branch L_fin
L_codeend:
.section .rodata,"a"
.p2align 6
.amdhsa_kernel gated_mix__sliding_block__ssm_conv_h3__prompt_kernel
  .amdhsa_next_free_vgpr 216
  .amdhsa_next_free_sgpr 102
  .amdhsa_accum_offset 216
  .amdhsa_group_segment_fixed_size 0
  .amdhsa_kernarg_size 104
  .amdhsa_user_sgpr_count 2
  .amdhsa_user_sgpr_kernarg_segment_ptr 1
  .amdhsa_system_sgpr_workgroup_id_x 1
  .amdhsa_float_denorm_mode_32 3
.end_amdhsa_kernel
```
